```python
import torch

def _softmax(x, axis=-1):
    return torch.softmax(x, dim=axis)
def _gelu(x):
    return torch.nn.functional.gelu(x, approximate="tanh")
def _silu(x):
    return torch.nn.functional.silu(x)
def _sigmoid(x):
    return torch.sigmoid(x)
def _layernorm(x, axis=-1, eps=1e-5):
    m = x.mean(dim=axis, keepdim=True)
    v = x.var(dim=axis, keepdim=True, unbiased=False)
    return (x - m) / torch.sqrt(v + eps)
def _scatter_add(tgt, idx, src, axis=0):
    return tgt.clone().index_add_(axis, idx, src)
def _segment_sum(src, seg, n):
    out = torch.zeros((n,) + src.shape[1:], dtype=src.dtype)
    return out.index_add_(0, seg, src)
def _pad(x, pw):
    flat = tuple(v for pair in reversed(pw) for v in pair)
    return torch.nn.functional.pad(x, flat)

kernel_name = 'standalone__paged_block_table_kv_radixattention__decode'

def setup_inputs():

    _w = (lambda a: (lambda t: t.to(torch.bfloat16) if t.is_floating_point() else t)(torch.as_tensor(a)))
    B, H, Hkv, Dh = 4, 16, 8, 256
    Lk = 4096
    bs = 16
    nb = max(2, Lk // bs)
    P = max(1, nb // 2)
    n_phys = P + B * (nb - P)
    shared = torch.arange(P, dtype=torch.int64)
    priv = P + torch.arange(B * (nb - P), dtype=torch.int64).reshape(B, nb - P)
    bt = torch.cat([torch.tile(shared[None, :], (B, 1)), priv], dim=1)
    ctx = nb * bs - (torch.arange(1, B + 1, dtype=torch.int64) * 2654435761) % max(1, (nb * bs - P * bs) // 2)
    return {
        "q": _w((lambda *s: torch.randn(*s, dtype=torch.bfloat16) * 0.8)(B, H, Dh)),
        "k_cache": _w((lambda *s: torch.randn(*s, dtype=torch.bfloat16) * 0.8)(n_phys, bs, Hkv, Dh)),
        "v_cache": _w((lambda *s: torch.randn(*s, dtype=torch.bfloat16) * 0.05)(n_phys, bs, Hkv, Dh)),
        "block_table": _w(bt.to(torch.int64)),
        "ctx_lens": _w(torch.as_tensor(ctx).to(torch.int64)),
    }

def reference(q, k_cache, v_cache, block_table, ctx_lens):
    B, H, Dh = q.shape
    n_phys, bs, Hkv, _ = k_cache.shape
    nb = block_table.shape[1]
    Lk = nb * bs
    rep = H // Hkv
    k = k_cache[block_table].reshape(B, Lk, Hkv, Dh)
    v = v_cache[block_table].reshape(B, Lk, Hkv, Dh)
    k = (lambda x, n, axis: torch.repeat_interleave(x, n, dim=axis))(k, rep, axis=2)
    v = (lambda x, n, axis: torch.repeat_interleave(x, n, dim=axis))(v, rep, axis=2)
    scores = torch.einsum("bhd,bkhd->bhk", q, k) * (Dh ** -0.5)
    pos = torch.arange(Lk)
    valid = pos[None, :] < ctx_lens[:, None]
    scores = torch.where(valid[:, None, :], scores, -1e9)
    p = _softmax(scores, axis=-1)
    return torch.einsum("bhk,bkhd->bhd", p, v)
```

```asm
; @launch grid=(256,1,1) block=(512,1,1) lds=8192
.amdgcn_target "amdgcn-amd-amdhsa--gfx950"
.text
.p2align 12
.globl standalone__paged_block_table_kv_radixattention__decode_kernel
.p2align 8
.type standalone__paged_block_table_kv_radixattention__decode_kernel,@function
standalone__paged_block_table_kv_radixattention__decode_kernel:
    s_load_dwordx2 s[24:25], s[0:1], 8
    s_cmp_ge_u32 s2, 256
    s_cbranch_scc1 L_end
    v_lshrrev_b32 v1, 6, v0
    v_and_b32 v0, 63, v0
    s_and_b32 s20, s2, 7
    v_readfirstlane_b32 s3, v1
    s_lshl_b32 s20, s20, 2
    s_lshr_b32 s20, 0x32541076, s20
    s_and_b32 s20, s20, 7
    s_lshr_b32 s21, s2, 3
    s_mul_i32 s50, s21, 21
    s_add_u32 s51, s50, 21
    s_lshr_b32 s50, s50, 2
    s_lshr_b32 s51, s51, 2
    s_mul_i32 s44, s21, 31
    s_lshr_b32 s45, s21, 3
    s_add_u32 s44, s44, s45
    s_sub_u32 s44, s44, s51
    s_sub_u32 s51, s51, s50
    s_addk_i32 s50, 1024
    s_and_b32 s45, s21, 7
    s_cmp_eq_u32 s45, 7
    s_cselect_b32 s45, 32, 31
    s_lshl_b32 s53, s20, 9
    s_mov_b32 s26, 41943040
    s_mov_b32 s27, 0x20000
    s_mov_b32 s55, 0
    s_cmp_ge_u32 s3, 4
    s_cbranch_scc1 L_vrole
    v_lshrrev_b32 v5, 1, v0
    v_bfe_u32 v6, v0, 3, 1
    v_and_or_b32 v5, v5, 24, v6
    v_lshl_add_u32 v6, s3, 1, v5
    v_add_u32 v3, s44, v6
    v_cmp_le_u32 vcc, 458, v3
    v_add_u32 v4, 54, v3
    v_and_b32 v1, 35, v0
    v_cndmask_b32 v4, v3, v4, vcc
    v_cmp_le_u32 vcc, 606, v3
    v_add_u32 v5, 108, v4
    v_mul_u32_u24 v1, 18, v1
    v_cndmask_b32 v4, v4, v5, vcc
    v_cmp_gt_u32 vcc, s51, v6
    v_add_u32 v5, s50, v6
    v_lshl_add_u32 v1, v0, 10, v1
    v_cndmask_b32 v4, v4, v5, vcc
    v_cmp_le_u32 vcc, s45, v6
    v_lshl_add_u32 v4, v4, 15, s53
    v_bfrev_b32 v5, 1
    v_cndmask_b32 v4, v4, v5, vcc
    v_and_b32 v1, 0x7070, v1
    v_readlane_b32 s64, v4, 0
    v_readlane_b32 s65, v4, 8
    v_readlane_b32 s66, v4, 16
    v_readlane_b32 s67, v4, 24
    v_readlane_b32 s68, v4, 32
    v_readlane_b32 s69, v4, 40
    v_readlane_b32 s70, v4, 48
    v_readlane_b32 s71, v4, 56
    s_waitcnt lgkmcnt(0)
L_kround:
    buffer_load_dwordx4 v[24:27], v1, s[24:27], s64 offen offset:0 nt
    buffer_load_dwordx4 v[28:31], v1, s[24:27], s64 offen offset:128 nt
    buffer_load_dwordx4 v[32:35], v1, s[24:27], s64 offen offset:256 nt
    buffer_load_dwordx4 v[36:39], v1, s[24:27], s64 offen offset:384 nt
    s_load_dwordx16 s[4:19], s[0:1], 0
    s_and_b32 s22, s3, 3
    s_lshl_b32 s54, s20, 7
    s_mov_b32 s30, 0x10000000
    s_mov_b32 s31, 0x20000
    buffer_load_dwordx4 v[40:43], v1, s[24:27], s65 offen offset:0 nt
    buffer_load_dwordx4 v[44:47], v1, s[24:27], s65 offen offset:128 nt
    buffer_load_dwordx4 v[48:51], v1, s[24:27], s65 offen offset:256 nt
    buffer_load_dwordx4 v[52:55], v1, s[24:27], s65 offen offset:384 nt
    s_waitcnt lgkmcnt(0)
    s_cmp_lg_u32 s55, 0
    s_cbranch_scc1 L_kepoch
    s_load_dword s48, s[18:19], s54
L_kepoch:
    s_mov_b32 s28, s18
    s_and_b32 s29, s19, 0xffff
    buffer_load_dwordx4 v[56:59], v1, s[24:27], s66 offen offset:0 nt
    buffer_load_dwordx4 v[60:63], v1, s[24:27], s66 offen offset:128 nt
    buffer_load_dwordx4 v[64:67], v1, s[24:27], s66 offen offset:256 nt
    buffer_load_dwordx4 v[68:71], v1, s[24:27], s66 offen offset:384 nt
    v_bfe_u32 v216, v0, 1, 2
    v_and_b32 v3, 1, v0
    v_lshlrev_b32 v3, 9, v3
    v_lshl_or_b32 v3, v216, 13, v3
    v_lshrrev_b32 v192, 3, v0
    v_lshl_or_b32 v3, v192, 4, v3
    s_lshl_b32 s56, s20, 10
    v_add_u32 v228, s56, v3
    v_lshlrev_b32 v227, 2, v216
    v_lshlrev_b32 v226, 4, v0
    v_and_b32 v232, 31, v0
    v_lshlrev_b32 v232, 2, v232
    s_getreg_b32 s47, hwreg(HW_REG_XCC_ID, 0, 3)
    s_lshl_b32 s47, s47, 29
    s_lshl_b32 s46, s21, 2
    s_add_u32 s46, s46, s54
    v_mov_b32 v231, s46
    s_waitcnt lgkmcnt(0)
    s_add_u32 s49, s48, 1
    s_and_b32 s56, s49, 0xff
    s_mul_i32 s56, s56, 0x01010100
    s_xor_b32 s59, s49, s56
    s_xor_b32 s47, s47, s59
    v_mov_b32 v230, s47
    s_cmp_eq_u32 s3, 0
    s_cselect_b64 exec, 1, 0
    buffer_store_dword v230, v231, s[28:31], 0 offen offset:2048
    s_mov_b64 exec, -1
    buffer_load_dwordx4 v[72:75], v1, s[24:27], s67 offen offset:0 nt
    buffer_load_dwordx4 v[76:79], v1, s[24:27], s67 offen offset:128 nt
    buffer_load_dwordx4 v[80:83], v1, s[24:27], s67 offen offset:256 nt
    buffer_load_dwordx4 v[84:87], v1, s[24:27], s67 offen offset:384 nt
    buffer_load_dwordx4 v[88:91], v1, s[24:27], s68 offen offset:0 nt
    buffer_load_dwordx4 v[92:95], v1, s[24:27], s68 offen offset:128 nt
    buffer_load_dwordx4 v[96:99], v1, s[24:27], s68 offen offset:256 nt
    buffer_load_dwordx4 v[100:103], v1, s[24:27], s68 offen offset:384 nt
    global_load_dword v212, v227, s[12:13]
    global_load_dwordx4 v[8:11], v228, s[4:5] offset:0
    global_load_dwordx4 v[12:15], v228, s[4:5] offset:128
    global_load_dwordx4 v[16:19], v228, s[4:5] offset:256
    global_load_dwordx4 v[20:23], v228, s[4:5] offset:384
    buffer_load_dwordx4 v[104:107], v1, s[24:27], s69 offen offset:0 nt
    buffer_load_dwordx4 v[108:111], v1, s[24:27], s69 offen offset:128 nt
    buffer_load_dwordx4 v[112:115], v1, s[24:27], s69 offen offset:256 nt
    buffer_load_dwordx4 v[116:119], v1, s[24:27], s69 offen offset:384 nt
    buffer_load_dwordx4 v[120:123], v1, s[24:27], s70 offen offset:0 nt
    buffer_load_dwordx4 v[124:127], v1, s[24:27], s70 offen offset:128 nt
    buffer_load_dwordx4 v[128:131], v1, s[24:27], s70 offen offset:256 nt
    buffer_load_dwordx4 v[132:135], v1, s[24:27], s70 offen offset:384 nt
    buffer_load_dwordx4 v[136:139], v1, s[24:27], s71 offen offset:0 nt
    buffer_load_dwordx4 v[140:143], v1, s[24:27], s71 offen offset:128 nt
    buffer_load_dwordx4 v[144:147], v1, s[24:27], s71 offen offset:256 nt
    buffer_load_dwordx4 v[148:151], v1, s[24:27], s71 offen offset:384 nt
    global_load_dwordx4 v[196:199], v226, s[10:11] offset:0
    global_load_dwordx4 v[200:203], v226, s[10:11] offset:1024
    global_load_dwordx4 v[204:207], v226, s[10:11] offset:2048
    global_load_dwordx4 v[208:211], v226, s[10:11] offset:3072
    buffer_load_dword v229, v232, s[28:31], s54 offen offset:2048 sc1
    s_barrier
    s_cmp_lg_u32 s55, 0
    s_cbranch_scc1 L_kconst_done
    v_bfe_u32 v7, v0, 3, 2
    v_lshrrev_b32 v3, 5, v0
    v_lshl_or_b32 v7, v7, 1, v3
    v_mov_b32 v213, 0x3db8aa3b
    v_mov_b32 v214, 0xf149f2ca
    v_mov_b32 v215, 0
    v_mov_b32 v220, 0xff800000
    v_lshlrev_b32 v194, 3, v216
    s_mov_b32 s56, 0xa8de94ca
    v_bfe_u32 v194, s56, v194, 8
    v_lshlrev_b32 v217, 8, v216
    v_add_u32 v217, 256, v217
    v_and_b32 v3, 7, v0
    v_lshlrev_b32 v218, 4, v3
    v_lshlrev_b32 v3, 1, v3
    v_bfe_u32 v192, v0, 3, 1
    v_and_b32 v195, 48, v0
    v_or3_b32 v3, v3, v192, v195
    s_lshl_b32 s56, s22, 2
    v_lshl_add_u32 v219, v3, 4, s56
    v_lshrrev_b32 v3, 15, v4
    v_sub_u32 v192, v3, v217
    v_min_u32 v192, 256, v192
    v_cmp_gt_u32 vcc, 256, v3
    v_add_u32 v192, 256, v192
    s_waitcnt vmcnt(21)
    v_cndmask_b32 v3, v192, v3, vcc
    v_mad_i32_i24 v5, v3, -8, v212
L_kconst_done:
    s_waitcnt vmcnt(17)
    v_mfma_f32_32x32x16_bf16 v[152:167], v[24:27], v[8:11], 0
    v_mfma_f32_32x32x16_bf16 v[152:167], v[28:31], v[12:15], v[152:167]
    v_mfma_f32_32x32x16_bf16 v[152:167], v[32:35], v[16:19], v[152:167]
    v_mfma_f32_32x32x16_bf16 v[152:167], v[36:39], v[20:23], v[152:167]
    s_waitcnt vmcnt(17)
    v_mfma_f32_32x32x16_bf16 v[168:183], v[40:43], v[8:11], 0
    v_mfma_f32_32x32x16_bf16 v[168:183], v[44:47], v[12:15], v[168:183]
    v_mfma_f32_32x32x16_bf16 v[168:183], v[48:51], v[16:19], v[168:183]
    v_mfma_f32_32x32x16_bf16 v[168:183], v[52:55], v[20:23], v[168:183]
    s_nop 7
    v_add_f32_dpp v184, v153, v152 row_ror:8 row_mask:0x5 bank_mask:0x3
    v_add_f32_dpp v184, v156, v157 row_ror:8 row_mask:0x5 bank_mask:0xc
    v_add_f32_dpp v184, v155, v154 row_ror:8 row_mask:0xa bank_mask:0x3
    v_add_f32_dpp v184, v158, v159 row_ror:8 row_mask:0xa bank_mask:0xc
    v_add_f32_dpp v192, v161, v160 row_ror:8 row_mask:0x5 bank_mask:0x3
    v_add_f32_dpp v192, v164, v165 row_ror:8 row_mask:0x5 bank_mask:0xc
    v_add_f32_dpp v192, v163, v162 row_ror:8 row_mask:0xa bank_mask:0x3
    v_add_f32_dpp v192, v166, v167 row_ror:8 row_mask:0xa bank_mask:0xc
    s_nop 1
    v_permlane16_swap_b32 v184, v192
    s_nop 0
    v_add_f32 v184, v184, v192
    s_waitcnt vmcnt(17)
    v_mfma_f32_32x32x16_bf16 v[152:167], v[56:59], v[8:11], 0
    v_mfma_f32_32x32x16_bf16 v[152:167], v[60:63], v[12:15], v[152:167]
    v_mfma_f32_32x32x16_bf16 v[152:167], v[64:67], v[16:19], v[152:167]
    v_mfma_f32_32x32x16_bf16 v[152:167], v[68:71], v[20:23], v[152:167]
    v_add_f32_dpp v185, v169, v168 row_ror:8 row_mask:0x5 bank_mask:0x3
    v_add_f32_dpp v185, v172, v173 row_ror:8 row_mask:0x5 bank_mask:0xc
    v_add_f32_dpp v185, v171, v170 row_ror:8 row_mask:0xa bank_mask:0x3
    v_add_f32_dpp v185, v174, v175 row_ror:8 row_mask:0xa bank_mask:0xc
    v_add_f32_dpp v193, v177, v176 row_ror:8 row_mask:0x5 bank_mask:0x3
    v_add_f32_dpp v193, v180, v181 row_ror:8 row_mask:0x5 bank_mask:0xc
    v_add_f32_dpp v193, v179, v178 row_ror:8 row_mask:0xa bank_mask:0x3
    v_add_f32_dpp v193, v182, v183 row_ror:8 row_mask:0xa bank_mask:0xc
    s_nop 1
    v_permlane16_swap_b32 v185, v193
    s_nop 0
    v_add_f32 v185, v185, v193
    s_waitcnt vmcnt(17)
    v_mfma_f32_32x32x16_bf16 v[168:183], v[72:75], v[8:11], 0
    v_mfma_f32_32x32x16_bf16 v[168:183], v[76:79], v[12:15], v[168:183]
    v_mfma_f32_32x32x16_bf16 v[168:183], v[80:83], v[16:19], v[168:183]
    v_mfma_f32_32x32x16_bf16 v[168:183], v[84:87], v[20:23], v[168:183]
    v_add_f32_dpp v186, v153, v152 row_ror:8 row_mask:0x5 bank_mask:0x3
    v_add_f32_dpp v186, v156, v157 row_ror:8 row_mask:0x5 bank_mask:0xc
    v_add_f32_dpp v186, v155, v154 row_ror:8 row_mask:0xa bank_mask:0x3
    v_add_f32_dpp v186, v158, v159 row_ror:8 row_mask:0xa bank_mask:0xc
    v_add_f32_dpp v192, v161, v160 row_ror:8 row_mask:0x5 bank_mask:0x3
    v_add_f32_dpp v192, v164, v165 row_ror:8 row_mask:0x5 bank_mask:0xc
    v_add_f32_dpp v192, v163, v162 row_ror:8 row_mask:0xa bank_mask:0x3
    v_add_f32_dpp v192, v166, v167 row_ror:8 row_mask:0xa bank_mask:0xc
    s_nop 1
    v_permlane16_swap_b32 v186, v192
    s_nop 0
    v_add_f32 v186, v186, v192
    s_waitcnt vmcnt(17)
    v_mfma_f32_32x32x16_bf16 v[152:167], v[88:91], v[8:11], 0
    v_mfma_f32_32x32x16_bf16 v[152:167], v[92:95], v[12:15], v[152:167]
    v_mfma_f32_32x32x16_bf16 v[152:167], v[96:99], v[16:19], v[152:167]
    v_mfma_f32_32x32x16_bf16 v[152:167], v[100:103], v[20:23], v[152:167]
    v_add_f32_dpp v187, v169, v168 row_ror:8 row_mask:0x5 bank_mask:0x3
    v_add_f32_dpp v187, v172, v173 row_ror:8 row_mask:0x5 bank_mask:0xc
    v_add_f32_dpp v187, v171, v170 row_ror:8 row_mask:0xa bank_mask:0x3
    v_add_f32_dpp v187, v174, v175 row_ror:8 row_mask:0xa bank_mask:0xc
    v_add_f32_dpp v193, v177, v176 row_ror:8 row_mask:0x5 bank_mask:0x3
    v_add_f32_dpp v193, v180, v181 row_ror:8 row_mask:0x5 bank_mask:0xc
    v_add_f32_dpp v193, v179, v178 row_ror:8 row_mask:0xa bank_mask:0x3
    v_add_f32_dpp v193, v182, v183 row_ror:8 row_mask:0xa bank_mask:0xc
    s_nop 1
    v_permlane16_swap_b32 v187, v193
    s_nop 0
    v_add_f32 v187, v187, v193
    s_waitcnt vmcnt(13)
    v_mfma_f32_32x32x16_bf16 v[168:183], v[104:107], v[8:11], 0
    v_mfma_f32_32x32x16_bf16 v[168:183], v[108:111], v[12:15], v[168:183]
    v_mfma_f32_32x32x16_bf16 v[168:183], v[112:115], v[16:19], v[168:183]
    v_mfma_f32_32x32x16_bf16 v[168:183], v[116:119], v[20:23], v[168:183]
    v_add_f32_dpp v188, v153, v152 row_ror:8 row_mask:0x5 bank_mask:0x3
    v_add_f32_dpp v188, v156, v157 row_ror:8 row_mask:0x5 bank_mask:0xc
    v_add_f32_dpp v188, v155, v154 row_ror:8 row_mask:0xa bank_mask:0x3
    v_add_f32_dpp v188, v158, v159 row_ror:8 row_mask:0xa bank_mask:0xc
    v_add_f32_dpp v192, v161, v160 row_ror:8 row_mask:0x5 bank_mask:0x3
    v_add_f32_dpp v192, v164, v165 row_ror:8 row_mask:0x5 bank_mask:0xc
    v_add_f32_dpp v192, v163, v162 row_ror:8 row_mask:0xa bank_mask:0x3
    v_add_f32_dpp v192, v166, v167 row_ror:8 row_mask:0xa bank_mask:0xc
    s_nop 1
    v_permlane16_swap_b32 v188, v192
    s_nop 0
    v_add_f32 v188, v188, v192
    s_waitcnt vmcnt(9)
    v_mfma_f32_32x32x16_bf16 v[152:167], v[120:123], v[8:11], 0
    v_mfma_f32_32x32x16_bf16 v[152:167], v[124:127], v[12:15], v[152:167]
    v_mfma_f32_32x32x16_bf16 v[152:167], v[128:131], v[16:19], v[152:167]
    v_mfma_f32_32x32x16_bf16 v[152:167], v[132:135], v[20:23], v[152:167]
    v_add_f32_dpp v189, v169, v168 row_ror:8 row_mask:0x5 bank_mask:0x3
    v_add_f32_dpp v189, v172, v173 row_ror:8 row_mask:0x5 bank_mask:0xc
    v_add_f32_dpp v189, v171, v170 row_ror:8 row_mask:0xa bank_mask:0x3
    v_add_f32_dpp v189, v174, v175 row_ror:8 row_mask:0xa bank_mask:0xc
    v_add_f32_dpp v193, v177, v176 row_ror:8 row_mask:0x5 bank_mask:0x3
    v_add_f32_dpp v193, v180, v181 row_ror:8 row_mask:0x5 bank_mask:0xc
    v_add_f32_dpp v193, v179, v178 row_ror:8 row_mask:0xa bank_mask:0x3
    v_add_f32_dpp v193, v182, v183 row_ror:8 row_mask:0xa bank_mask:0xc
    s_nop 1
    v_permlane16_swap_b32 v189, v193
    s_nop 0
    v_add_f32 v189, v189, v193
    s_waitcnt vmcnt(5)
    v_mfma_f32_32x32x16_bf16 v[168:183], v[136:139], v[8:11], 0
    v_mfma_f32_32x32x16_bf16 v[168:183], v[140:143], v[12:15], v[168:183]
    v_mfma_f32_32x32x16_bf16 v[168:183], v[144:147], v[16:19], v[168:183]
    v_mfma_f32_32x32x16_bf16 v[168:183], v[148:151], v[20:23], v[168:183]
    v_add_f32_dpp v190, v153, v152 row_ror:8 row_mask:0x5 bank_mask:0x3
    v_add_f32_dpp v190, v156, v157 row_ror:8 row_mask:0x5 bank_mask:0xc
    v_add_f32_dpp v190, v155, v154 row_ror:8 row_mask:0xa bank_mask:0x3
    v_add_f32_dpp v190, v158, v159 row_ror:8 row_mask:0xa bank_mask:0xc
    v_add_f32_dpp v192, v161, v160 row_ror:8 row_mask:0x5 bank_mask:0x3
    v_add_f32_dpp v192, v164, v165 row_ror:8 row_mask:0x5 bank_mask:0xc
    v_add_f32_dpp v192, v163, v162 row_ror:8 row_mask:0xa bank_mask:0x3
    v_add_f32_dpp v192, v166, v167 row_ror:8 row_mask:0xa bank_mask:0xc
    s_nop 1
    v_permlane16_swap_b32 v190, v192
    s_nop 0
    v_add_f32 v190, v190, v192
    v_add_f32_dpp v191, v169, v168 row_ror:8 row_mask:0x5 bank_mask:0x3
    v_add_f32_dpp v191, v172, v173 row_ror:8 row_mask:0x5 bank_mask:0xc
    v_add_f32_dpp v191, v171, v170 row_ror:8 row_mask:0xa bank_mask:0x3
    v_add_f32_dpp v191, v174, v175 row_ror:8 row_mask:0xa bank_mask:0xc
    v_add_f32_dpp v193, v177, v176 row_ror:8 row_mask:0x5 bank_mask:0x3
    v_add_f32_dpp v193, v180, v181 row_ror:8 row_mask:0x5 bank_mask:0xc
    v_add_f32_dpp v193, v179, v178 row_ror:8 row_mask:0xa bank_mask:0x3
    v_add_f32_dpp v193, v182, v183 row_ror:8 row_mask:0xa bank_mask:0xc
    s_nop 1
    v_permlane16_swap_b32 v191, v193
    s_nop 0
    v_add_f32 v191, v191, v193
    v_mul_f32 v184, v184, v213
    v_mul_f32 v185, v185, v213
    v_mul_f32 v186, v186, v213
    v_mul_f32 v187, v187, v213
    v_mul_f32 v188, v188, v213
    v_mul_f32 v189, v189, v213
    v_mul_f32 v190, v190, v213
    v_mul_f32 v191, v191, v213
    s_cmp_lg_u32 s55, 0
    s_cbranch_scc1 L_kverified
    s_mov_b32 s57, 0
    s_mov_b32 s58, 0
    v_lshlrev_b32 v152, 2, v0
    v_add_u32 v153, 1, v152
    v_add_u32 v154, 2, v152
    v_add_u32 v155, 3, v152
    v_and_b32 v156, 32, v0
    v_lshlrev_b32 v156, 2, v156
    v_add_u32 v157, -2041, v212
    v_lshrrev_b32 v157, 3, v157
    v_xor_b32 v157, v157, v194
    s_waitcnt vmcnt(0)
    v_xor_b32 v196, v196, v152
    v_xor_b32 v197, v197, v153
    v_xor_b32 v198, v198, v154
    v_xor_b32 v199, v199, v155
    v_add_u32 v152, v152, v156
    v_add_u32 v153, v153, v156
    v_add_u32 v154, v154, v156
    v_add_u32 v155, v155, v156
    v_or3_b32 v157, v157, v196, v197
    v_or3_b32 v157, v157, v198, v199
    v_xor_b32 v200, v200, v152
    v_xor_b32 v201, v201, v153
    v_xor_b32 v202, v202, v154
    v_xor_b32 v203, v203, v155
    v_add_u32 v152, v152, v156
    v_add_u32 v153, v153, v156
    v_add_u32 v154, v154, v156
    v_add_u32 v155, v155, v156
    v_or3_b32 v157, v157, v200, v201
    v_or3_b32 v157, v157, v202, v203
    v_xor_b32 v204, v204, v152
    v_xor_b32 v205, v205, v153
    v_xor_b32 v206, v206, v154
    v_xor_b32 v207, v207, v155
    v_add_u32 v152, v152, v156
    v_add_u32 v153, v153, v156
    v_add_u32 v154, v154, v156
    v_add_u32 v155, v155, v156
    v_or3_b32 v157, v157, v204, v205
    v_or3_b32 v157, v157, v206, v207
    v_xor_b32 v208, v208, v152
    v_xor_b32 v209, v209, v153
    v_xor_b32 v210, v210, v154
    v_xor_b32 v211, v211, v155
    v_or3_b32 v157, v157, v208, v209
    v_or3_b32 v157, v157, v210, v211
    v_cmp_ne_u32 vcc, 0, v157
    s_cmp_lg_u64 vcc, 0
    s_cbranch_scc1 L_slow
L_kverified:
    s_waitcnt vmcnt(0)
    v_cmp_ne_u32 vcc, v229, v230
    s_cmp_eq_u64 vcc, 0
    s_cselect_b32 s44, 4, 0
    s_or_b32 s57, s57, s44
    v_lshrrev_b32 v153, 2, v218
    ds_bpermute_b32 v236, v153, v5 offset:0
    ds_bpermute_b32 v237, v153, v5 offset:32
    ds_bpermute_b32 v238, v153, v5 offset:64
    ds_bpermute_b32 v239, v153, v5 offset:96
    ds_bpermute_b32 v240, v153, v5 offset:128
    ds_bpermute_b32 v241, v153, v5 offset:160
    ds_bpermute_b32 v242, v153, v5 offset:192
    ds_bpermute_b32 v243, v153, v5 offset:224
    s_waitcnt lgkmcnt(0)
    v_cmp_lt_i32 s[68:69], v7, v236
    v_cmp_lt_i32 s[70:71], v7, v237
    v_cmp_lt_i32 s[72:73], v7, v238
    v_cmp_lt_i32 s[74:75], v7, v239
    v_cmp_lt_i32 s[76:77], v7, v240
    v_cmp_lt_i32 s[78:79], v7, v241
    v_cmp_lt_i32 s[80:81], v7, v242
    v_cmp_lt_i32 s[82:83], v7, v243
    s_nop 0
    v_cndmask_b32 v184, v220, v184, s[68:69]
    v_cndmask_b32 v185, v220, v185, s[70:71]
    v_cndmask_b32 v186, v220, v186, s[72:73]
    v_cndmask_b32 v187, v220, v187, s[74:75]
    v_cndmask_b32 v188, v220, v188, s[76:77]
    v_cndmask_b32 v189, v220, v189, s[78:79]
    v_cndmask_b32 v190, v220, v190, s[80:81]
    v_cndmask_b32 v191, v220, v191, s[82:83]
    v_max3_f32 v152, v184, v185, v186
    v_max3_f32 v153, v187, v188, v189
    v_max3_f32 v152, v152, v190, v191
    v_max_f32 v152, v152, v153
    s_nop 1
    v_max_f32_dpp v152, v152, v152 row_ror:8 row_mask:0xf bank_mask:0xf
    v_mov_b32 v153, v152
    s_nop 1
    v_permlane16_swap_b32 v152, v153
    s_nop 0
    v_max_f32 v152, v152, v153
    v_mov_b32 v153, v152
    s_nop 1
    v_permlane32_swap_b32 v152, v153
    s_nop 0
    v_max_f32 v152, v152, v153
    s_lshl_b32 s56, s22, 2
    v_add_u32 v154, s56, v218
    ds_write_b32 v154, v152 offset:4096
    s_waitcnt lgkmcnt(0)
    s_barrier
    ds_read_b128 v[156:159], v218 offset:4096
    s_waitcnt lgkmcnt(0)
    v_max3_f32 v152, v156, v157, v158
    v_max3_f32 v152, v152, v159, v214
    v_sub_f32 v221, v214, v152
    v_mov_b32 v214, v152
    v_sub_f32 v184, v184, v152
    v_sub_f32 v185, v185, v152
    v_sub_f32 v186, v186, v152
    v_sub_f32 v187, v187, v152
    v_sub_f32 v188, v188, v152
    v_sub_f32 v189, v189, v152
    v_sub_f32 v190, v190, v152
    v_sub_f32 v191, v191, v152
    v_exp_f32 v221, v221
    v_exp_f32 v184, v184
    v_exp_f32 v185, v185
    v_exp_f32 v186, v186
    v_exp_f32 v187, v187
    v_exp_f32 v188, v188
    v_exp_f32 v189, v189
    v_exp_f32 v190, v190
    v_exp_f32 v191, v191
    v_lshrrev_b32 v153, 2, v218
    v_cvt_pk_bf16_f32 v156, v184, v185
    v_cvt_pk_bf16_f32 v157, v186, v187
    v_cvt_pk_bf16_f32 v158, v188, v189
    v_cvt_pk_bf16_f32 v159, v190, v191
    ds_write2st64_b32 v219, v156, v157 offset0:0 offset1:4
    ds_write2st64_b32 v219, v158, v159 offset0:8 offset1:12
    ds_write_b32 v153, v214 offset:4352
    ds_write_b32 v153, v221 offset:4384
    v_mov_b32 v160, 0
    v_mov_b32 v161, s57
    ds_write_b32 v160, v161 offset:4416
    v_add_f32 v152, v184, v185
    v_add_f32 v163, v186, v187
    v_add_f32 v155, v188, v189
    v_add_f32 v162, v190, v191
    v_add_f32 v152, v152, v163
    v_add_f32 v155, v155, v162
    v_add_f32 v152, v152, v155
    s_nop 1
    v_add_f32_dpp v152, v152, v152 row_ror:8 row_mask:0xf bank_mask:0xf
    v_mov_b32 v163, v152
    s_nop 1
    v_permlane16_swap_b32 v152, v163
    s_nop 0
    v_add_f32 v152, v152, v163
    v_mov_b32 v163, v152
    s_nop 1
    v_permlane32_swap_b32 v152, v163
    s_nop 0
    v_add_f32 v152, v152, v163
    ds_write_b32 v154, v152 offset:4224
    s_waitcnt lgkmcnt(0)
    s_barrier
    ds_read_b128 v[156:159], v218 offset:4224
    s_waitcnt lgkmcnt(0)
    v_add_f32 v156, v156, v157
    v_add_f32 v158, v158, v159
    v_add_f32 v156, v156, v158
    v_fma_f32 v215, v215, v221, v156
    s_cmp_lg_u32 s58, 0
    s_cbranch_scc1 L_knext
    s_lshl_b32 s56, s20, 8
    s_add_u32 s56, s56, s21
    s_lshl_b32 s56, s56, 4
    s_add_u32 s56, s56, 4096
    v_lshl_add_u32 v152, v218, 5, s56
    v_mov_b32 v156, v214
    v_mov_b32 v157, v215
    v_xor_b32 v158, v214, v215
    v_xor_b32 v158, s59, v158
    v_mov_b32 v159, v158
    s_cmp_eq_u32 s3, 0
    s_cselect_b64 s[44:45], 0xff, 0
    s_bitcmp1_b32 s57, 2
    s_cselect_b64 exec, s[44:45], 0
    buffer_store_dwordx4 v[156:159], v152, s[28:31], 0 offen
    s_cselect_b64 exec, 0, s[44:45]
    buffer_store_dwordx4 v[156:159], v152, s[28:31], 0 offen sc1
    s_mov_b64 exec, -1
    s_lshr_b32 s60, s21, 2
    s_lshl_b32 s56, s20, 3
    s_add_u32 s56, s56, s60
    s_lshl_b32 s56, s56, 9
    s_add_u32 s56, s56, 4096
    v_lshrrev_b32 v24, 2, v0
    v_lshl_add_u32 v25, v24, 4, s56
    s_lshl_b32 s56, s20, 5
    s_add_u32 s56, s56, s21
    s_lshl_b32 s56, s56, 13
    s_lshl_b32 s61, s22, 6
    s_add_u32 s56, s56, s61
    s_add_u32 s56, s56, 524288
    v_and_b32 v27, 3, v0
    v_lshlrev_b32 v26, 8, v24
    v_lshl_or_b32 v26, v27, 4, v26
    v_add_u32 v26, s56, v26
    s_mov_b32 s61, 4096
    s_mov_b32 s62, 0x0c0c0400
    s_mov_b32 s63, 0x200000
    s_mov_b32 s36, s14
    s_and_b32 s37, s15, 0xffff
    s_mov_b32 s38, 32768
    s_mov_b32 s39, 0x20000
    s_lshr_b32 s56, s60, 1
    s_lshl_b32 s56, s56, 13
    s_and_b32 s40, s60, 1
    s_lshl_b32 s40, s40, 9
    s_add_u32 s56, s56, s40
    s_lshl_b32 s40, s20, 10
    s_add_u32 s56, s56, s40
    s_and_b32 s40, s21, 3
    s_lshl_b32 s40, s40, 7
    s_add_u32 s56, s56, s40
    s_and_b32 s40, s22, 1
    s_lshl_b32 s40, s40, 6
    s_add_u32 s56, s56, s40
    s_lshr_b32 s40, s22, 1
    s_lshl_b32 s40, s40, 3
    s_add_u32 s56, s56, s40
    v_lshrrev_b32 v28, 4, v0
    v_lshlrev_b32 v28, 1, v28
    v_lshl_or_b32 v28, v27, 4, v28
    v_add_u32 v28, s56, v28
    s_andn2_b32 s40, 0xff, s59
    v_mov_b32 v40, s40
    v_mov_b32 v41, 0
    v_mov_b32 v42, 0
    v_mov_b32 v43, 0
    v_mov_b32 v44, s40
    v_mov_b32 v45, 0
    v_mov_b32 v46, 0
    v_mov_b32 v47, 0
    s_barrier
L_poll1:
    buffer_load_dwordx3 v[32:34], v25, s[28:31], 0 offen sc1
    buffer_load_dwordx3 v[36:38], v25, s[28:31], 0 offen offset:256 sc1
    s_sub_u32 s63, s63, 1
    s_cbranch_scc1 L_end
    s_waitcnt vmcnt(0)
    v_xor_b32 v29, v32, v33
    v_xor_b32 v30, v36, v37
    v_xor_b32 v29, v29, v34
    v_xor_b32 v30, v30, v38
    v_cmp_ne_u32 vcc, s59, v29
    v_cmp_ne_u32 s[40:41], s59, v30
    s_or_b64 vcc, vcc, s[40:41]
    s_cbranch_scc1 L_poll1
    v_mov_b32 v56, s54
    v_mov_b32 v57, s49
    s_or_b32 s56, s21, s3
    s_cselect_b64 exec, 0, 1
    buffer_store_dword v57, v56, s[28:31], 0 offen
    s_mov_b64 exec, -1
    v_max_f32 v29, v32, v36
    s_nop 1
    v_max_f32_dpp v29, v29, v29 row_ror:4 row_mask:0xf bank_mask:0xf
    s_nop 1
    v_max_f32_dpp v29, v29, v29 row_ror:8 row_mask:0xf bank_mask:0xf
    v_mov_b32 v30, v29
    s_nop 1
    v_permlane16_swap_b32 v29, v30
    s_nop 0
    v_max_f32 v29, v29, v30
    v_mov_b32 v30, v29
    s_nop 1
    v_permlane32_swap_b32 v29, v30
    s_nop 0
    v_max_f32 v29, v29, v30
    v_sub_f32 v32, v32, v29
    v_sub_f32 v36, v36, v29
    v_exp_f32 v32, v32
    v_exp_f32 v36, v36
    v_cmp_lt_f32 s[42:43], 0, v33
    v_cmp_lt_f32 s[44:45], 0, v37
    v_mul_f32 v29, v32, v33
    v_fmac_f32 v29, v36, v37
    s_nop 1
    v_add_f32_dpp v29, v29, v29 row_ror:4 row_mask:0xf bank_mask:0xf
    s_nop 1
    v_add_f32_dpp v29, v29, v29 row_ror:8 row_mask:0xf bank_mask:0xf
    v_mov_b32 v30, v29
    s_nop 1
    v_permlane16_swap_b32 v29, v30
    s_nop 0
    v_add_f32 v29, v29, v30
    v_mov_b32 v30, v29
    s_nop 1
    v_permlane32_swap_b32 v29, v30
    s_nop 0
    v_add_f32 v29, v29, v30
    v_rcp_f32 v29, v29
    s_nop 0
    v_mul_f32 v32, v32, v29
    v_mul_f32 v36, v36, v29
L_poll2:
    s_mov_b64 exec, s[42:43]
    buffer_load_dwordx4 v[40:43], v26, s[28:31], 0 offen sc1
    s_mov_b64 exec, s[44:45]
    buffer_load_dwordx4 v[44:47], v26, s[28:31], s61 offen sc1
    s_mov_b64 exec, -1
    s_sub_u32 s63, s63, 1
    s_cbranch_scc1 L_end
    s_waitcnt vmcnt(1)
    v_perm_b32 v48, v41, v40, s62
    v_perm_b32 v49, v43, v42, s62
    v_lshl_or_b32 v48, v49, 16, v48
    v_cmp_ne_u32 vcc, s59, v48
    s_waitcnt vmcnt(0)
    v_perm_b32 v50, v45, v44, s62
    v_perm_b32 v51, v47, v46, s62
    s_and_b64 s[42:43], s[42:43], vcc
    v_lshl_or_b32 v50, v51, 16, v50
    v_cmp_ne_u32 vcc, s59, v50
    v_mul_f32 v52, v40, v32
    v_mul_f32 v53, v41, v32
    v_mul_f32 v54, v42, v32
    v_mul_f32 v55, v43, v32
    s_and_b64 s[44:45], s[44:45], vcc
    s_or_b64 s[40:41], s[42:43], s[44:45]
    s_cbranch_scc1 L_poll2
    v_fmac_f32 v52, v44, v36
    v_fmac_f32 v54, v46, v36
    v_fmac_f32 v53, v45, v36
    v_fmac_f32 v55, v47, v36
    v_permlane32_swap_b32 v52, v54
    s_nop 0
    v_permlane32_swap_b32 v53, v55
    v_add_f32 v52, v52, v54
    v_add_f32 v53, v53, v55
    s_mov_b32 s40, 0x000f000f
    s_mov_b32 s41, 0x000f000f
    v_permlane16_swap_b32 v52, v53
    v_add_f32 v52, v52, v53
    s_nop 1
    v_add_f32_dpp v52, v52, v52 row_ror:8 row_mask:0xf bank_mask:0xf
    s_nop 1
    v_add_f32_dpp v52, v52, v52 row_ror:4 row_mask:0xf bank_mask:0xf
    s_mov_b64 exec, s[40:41]
    v_cvt_pk_bf16_f32 v52, v52, v52
    buffer_store_short v52, v28, s[36:39], 0 offen
L_end:
    s_endpgm
L_vrole:
    s_load_dwordx16 s[4:19], s[0:1], 0
    s_and_b32 s22, s3, 3
    s_lshl_b32 s54, s20, 7
    s_mov_b32 s30, 0x10000000
    s_mov_b32 s31, 0x20000
    v_and_b32 v6, 31, v0
    v_add_u32 v3, s44, v6
    v_cmp_le_u32 vcc, 458, v3
    v_add_u32 v4, 54, v3
    s_nop 0
    v_cndmask_b32 v4, v3, v4, vcc
    v_cmp_le_u32 vcc, 606, v3
    v_add_u32 v5, 108, v4
    s_nop 0
    v_cndmask_b32 v4, v4, v5, vcc
    v_cmp_gt_u32 vcc, s51, v6
    v_add_u32 v5, s50, v6
    s_nop 0
    v_cndmask_b32 v4, v4, v5, vcc
    v_cmp_le_u32 vcc, s45, v6
    v_lshl_add_u32 v4, v4, 15, s53
    v_bfrev_b32 v5, 1
    v_cndmask_b32 v4, v4, v5, vcc
    v_bfe_u32 v7, v0, 3, 2
    v_lshrrev_b32 v3, 5, v0
    v_lshl_or_b32 v7, v7, 1, v3
    v_readlane_b32 s64, v4, 0
    v_readlane_b32 s65, v4, 1
    v_readlane_b32 s66, v4, 2
    v_readlane_b32 s67, v4, 3
    v_readlane_b32 s68, v4, 4
    v_readlane_b32 s69, v4, 5
    v_readlane_b32 s70, v4, 6
    v_readlane_b32 s71, v4, 7
    v_readlane_b32 s72, v4, 8
    v_readlane_b32 s73, v4, 9
    v_readlane_b32 s74, v4, 10
    v_readlane_b32 s75, v4, 11
    v_readlane_b32 s76, v4, 12
    v_readlane_b32 s77, v4, 13
    v_readlane_b32 s78, v4, 14
    v_readlane_b32 s79, v4, 15
    v_and_b32 v3, 7, v0
    v_lshlrev_b32 v1, 12, v7
    v_lshl_or_b32 v1, v3, 4, v1
    s_lshl_b32 s56, s22, 7
    v_add_u32 v1, s56, v1
    s_waitcnt lgkmcnt(0)
    s_mov_b32 s24, s8
    s_and_b32 s25, s9, 0xffff
    s_load_dword s48, s[18:19], s54
    s_mov_b32 s28, s18
    s_and_b32 s29, s19, 0xffff
    v_mov_b32 v184, 0
    v_mov_b32 v185, 0
    v_mov_b32 v186, 0
    v_mov_b32 v187, 0
    v_mov_b32 v188, 0
    v_mov_b32 v189, 0
    v_mov_b32 v190, 0
    v_mov_b32 v191, 0
    v_mov_b32 v192, 0
    v_mov_b32 v193, 0
    v_mov_b32 v194, 0
    v_mov_b32 v195, 0
    v_mov_b32 v196, 0
    v_mov_b32 v197, 0
    v_mov_b32 v198, 0
    v_mov_b32 v199, 0
    v_mov_b32 v200, 0
    v_mov_b32 v201, 0
    v_mov_b32 v202, 0
    v_mov_b32 v203, 0
    v_mov_b32 v204, 0
    v_mov_b32 v205, 0
    v_mov_b32 v206, 0
    v_mov_b32 v207, 0
    v_mov_b32 v208, 0
    v_mov_b32 v209, 0
    v_mov_b32 v210, 0
    v_mov_b32 v211, 0
    v_mov_b32 v212, 0
    v_mov_b32 v213, 0
    v_mov_b32 v214, 0
    v_mov_b32 v215, 0
    v_lshlrev_b32 v8, 4, v0
    v_lshrrev_b32 v9, 3, v0
    v_lshlrev_b32 v10, 15, v9
    v_lshl_or_b32 v10, v3, 4, v10
    s_lshl_b32 s56, s20, 18
    s_lshl_b32 s57, s22, 13
    s_add_u32 s56, s56, s57
    s_lshl_b32 s57, s21, 8
    s_add_u32 s56, s56, s57
    s_add_u32 s56, s56, 524288
    v_add_u32 v10, s56, v10
    v_lshlrev_b32 v9, 2, v9
    s_mov_b32 s60, 0x05040100
    s_mov_b32 s61, 0x07060302
    s_mov_b32 s40, 0x07060500
    s_mov_b32 s41, 0x07060501
    s_mov_b32 s42, 0x07060502
    s_mov_b32 s43, 0x07060503
    v_mov_b32 v15, 0xf149f2ca
    s_waitcnt lgkmcnt(0)
    s_add_u32 s49, s48, 1
    s_and_b32 s56, s49, 0xff
    s_mul_i32 s56, s56, 0x01010100
    s_xor_b32 s59, s49, s56
    v_mov_b32 v11, s59
L_vround:
    v_mov_b32 v12, 0
    s_barrier
    buffer_load_dwordx4 v[24:27], v1, s[24:27], s64 offen nt
    buffer_load_dwordx4 v[28:31], v1, s[24:27], s65 offen nt
    v_readlane_b32 s64, v4, 16
    buffer_load_dwordx4 v[32:35], v1, s[24:27], s66 offen nt
    v_readlane_b32 s65, v4, 17
    buffer_load_dwordx4 v[36:39], v1, s[24:27], s67 offen nt
    v_readlane_b32 s66, v4, 18
    buffer_load_dwordx4 v[40:43], v1, s[24:27], s68 offen nt
    v_readlane_b32 s67, v4, 19
    buffer_load_dwordx4 v[44:47], v1, s[24:27], s69 offen nt
    v_readlane_b32 s68, v4, 20
    buffer_load_dwordx4 v[48:51], v1, s[24:27], s70 offen nt
    v_readlane_b32 s69, v4, 21
    s_waitcnt vmcnt(6)
    buffer_load_dwordx4 v[52:55], v1, s[24:27], s71 offen nt
    v_readlane_b32 s70, v4, 22
    s_waitcnt vmcnt(6)
    buffer_load_dwordx4 v[56:59], v1, s[24:27], s72 offen nt
    v_readlane_b32 s71, v4, 23
    s_waitcnt vmcnt(6)
    buffer_load_dwordx4 v[60:63], v1, s[24:27], s73 offen nt
    v_readlane_b32 s72, v4, 24
    s_barrier
    s_waitcnt vmcnt(6)
    buffer_load_dwordx4 v[64:67], v1, s[24:27], s74 offen nt
    v_readlane_b32 s73, v4, 25
    s_barrier
    ds_read_b32 v13, v9 offset:4352
    ds_read_b32 v12, v12 offset:4416
    ds_read_b128 v[216:219], v8 offset:0
    ds_read_b128 v[220:223], v8 offset:1024
    ds_read_b128 v[224:227], v8 offset:2048
    ds_read_b128 v[228:231], v8 offset:3072
    s_waitcnt vmcnt(6)
    buffer_load_dwordx4 v[68:71], v1, s[24:27], s75 offen nt
    v_readlane_b32 s74, v4, 26
    s_waitcnt lgkmcnt(0)
    v_readfirstlane_b32 s57, v12
    v_cmp_lt_f32 s[46:47], v15, v13
    s_waitcnt vmcnt(6)
    buffer_load_dwordx4 v[72:75], v1, s[24:27], s76 offen nt
    v_readlane_b32 s75, v4, 27
    s_waitcnt vmcnt(6)
    buffer_load_dwordx4 v[76:79], v1, s[24:27], s77 offen nt
    v_readlane_b32 s76, v4, 28
    s_waitcnt vmcnt(6)
    buffer_load_dwordx4 v[80:83], v1, s[24:27], s78 offen nt
    v_readlane_b32 s77, v4, 29
    s_waitcnt vmcnt(6)
    buffer_load_dwordx4 v[84:87], v1, s[24:27], s79 offen nt
    v_readlane_b32 s78, v4, 30
    s_waitcnt vmcnt(6)
    buffer_load_dwordx4 v[88:91], v1, s[24:27], s64 offen nt
    v_readlane_b32 s79, v4, 31
    s_waitcnt vmcnt(6)
    buffer_load_dwordx4 v[92:95], v1, s[24:27], s65 offen nt
    s_waitcnt vmcnt(6)
    buffer_load_dwordx4 v[96:99], v1, s[24:27], s66 offen nt
    s_waitcnt vmcnt(6)
    buffer_load_dwordx4 v[100:103], v1, s[24:27], s67 offen nt
    s_waitcnt vmcnt(6)
    buffer_load_dwordx4 v[104:107], v1, s[24:27], s68 offen nt
    s_waitcnt vmcnt(6)
    buffer_load_dwordx4 v[108:111], v1, s[24:27], s69 offen nt
    s_waitcnt vmcnt(6)
    buffer_load_dwordx4 v[112:115], v1, s[24:27], s70 offen nt
    s_waitcnt vmcnt(6)
    buffer_load_dwordx4 v[116:119], v1, s[24:27], s71 offen nt
    buffer_load_dwordx4 v[120:123], v1, s[24:27], s72 offen nt
    s_barrier
    buffer_load_dwordx4 v[124:127], v1, s[24:27], s73 offen nt
    buffer_load_dwordx4 v[128:131], v1, s[24:27], s74 offen nt
    buffer_load_dwordx4 v[132:135], v1, s[24:27], s75 offen nt
    buffer_load_dwordx4 v[136:139], v1, s[24:27], s76 offen nt
    buffer_load_dwordx4 v[140:143], v1, s[24:27], s77 offen nt
    buffer_load_dwordx4 v[144:147], v1, s[24:27], s78 offen nt
    buffer_load_dwordx4 v[148:151], v1, s[24:27], s79 offen nt
    s_and_b32 s56, s57, 3
    s_or_b32 s56, s56, s55
    s_cbranch_scc1 L_vspecial
L_vpv:
    s_waitcnt vmcnt(30)
    v_perm_b32 v152, v28, v24, s60
    v_perm_b32 v156, v28, v24, s61
    v_perm_b32 v160, v29, v25, s60
    v_perm_b32 v164, v29, v25, s61
    v_perm_b32 v168, v30, v26, s60
    v_perm_b32 v172, v30, v26, s61
    v_perm_b32 v176, v31, v27, s60
    v_perm_b32 v180, v31, v27, s61
    s_waitcnt vmcnt(28)
    v_perm_b32 v153, v36, v32, s60
    v_perm_b32 v157, v36, v32, s61
    v_perm_b32 v161, v37, v33, s60
    v_perm_b32 v165, v37, v33, s61
    v_perm_b32 v169, v38, v34, s60
    v_perm_b32 v173, v38, v34, s61
    v_perm_b32 v177, v39, v35, s60
    v_perm_b32 v181, v39, v35, s61
    s_waitcnt vmcnt(26)
    v_perm_b32 v154, v44, v40, s60
    v_perm_b32 v158, v44, v40, s61
    v_perm_b32 v162, v45, v41, s60
    v_perm_b32 v166, v45, v41, s61
    v_perm_b32 v170, v46, v42, s60
    v_perm_b32 v174, v46, v42, s61
    v_perm_b32 v178, v47, v43, s60
    v_perm_b32 v182, v47, v43, s61
    s_waitcnt vmcnt(24)
    v_perm_b32 v155, v52, v48, s60
    v_perm_b32 v159, v52, v48, s61
    v_perm_b32 v163, v53, v49, s60
    v_perm_b32 v167, v53, v49, s61
    v_mfma_f32_16x16x32_bf16 v[184:187], v[216:219], v[152:155], v[184:187]
    v_mfma_f32_16x16x32_bf16 v[188:191], v[216:219], v[156:159], v[188:191]
    v_perm_b32 v171, v54, v50, s60
    v_perm_b32 v175, v54, v50, s61
    v_mfma_f32_16x16x32_bf16 v[192:195], v[216:219], v[160:163], v[192:195]
    v_mfma_f32_16x16x32_bf16 v[196:199], v[216:219], v[164:167], v[196:199]
    v_perm_b32 v179, v55, v51, s60
    v_perm_b32 v183, v55, v51, s61
    v_mfma_f32_16x16x32_bf16 v[200:203], v[216:219], v[168:171], v[200:203]
    v_mfma_f32_16x16x32_bf16 v[204:207], v[216:219], v[172:175], v[204:207]
    v_mfma_f32_16x16x32_bf16 v[208:211], v[216:219], v[176:179], v[208:211]
    v_mfma_f32_16x16x32_bf16 v[212:215], v[216:219], v[180:183], v[212:215]
    s_waitcnt vmcnt(22)
    v_perm_b32 v152, v60, v56, s60
    v_perm_b32 v156, v60, v56, s61
    v_perm_b32 v160, v61, v57, s60
    v_perm_b32 v164, v61, v57, s61
    v_perm_b32 v168, v62, v58, s60
    v_perm_b32 v172, v62, v58, s61
    v_perm_b32 v176, v63, v59, s60
    v_perm_b32 v180, v63, v59, s61
    s_waitcnt vmcnt(20)
    v_perm_b32 v153, v68, v64, s60
    v_perm_b32 v157, v68, v64, s61
    v_perm_b32 v161, v69, v65, s60
    v_perm_b32 v165, v69, v65, s61
    v_perm_b32 v169, v70, v66, s60
    v_perm_b32 v173, v70, v66, s61
    v_perm_b32 v177, v71, v67, s60
    v_perm_b32 v181, v71, v67, s61
    s_waitcnt vmcnt(18)
    v_perm_b32 v154, v76, v72, s60
    v_perm_b32 v158, v76, v72, s61
    v_perm_b32 v162, v77, v73, s60
    v_perm_b32 v166, v77, v73, s61
    v_perm_b32 v170, v78, v74, s60
    v_perm_b32 v174, v78, v74, s61
    v_perm_b32 v178, v79, v75, s60
    v_perm_b32 v182, v79, v75, s61
    s_waitcnt vmcnt(16)
    v_perm_b32 v155, v84, v80, s60
    v_perm_b32 v159, v84, v80, s61
    v_perm_b32 v163, v85, v81, s60
    v_perm_b32 v167, v85, v81, s61
    v_mfma_f32_16x16x32_bf16 v[184:187], v[220:223], v[152:155], v[184:187]
    v_mfma_f32_16x16x32_bf16 v[188:191], v[220:223], v[156:159], v[188:191]
    v_perm_b32 v171, v86, v82, s60
    v_perm_b32 v175, v86, v82, s61
    v_mfma_f32_16x16x32_bf16 v[192:195], v[220:223], v[160:163], v[192:195]
    v_mfma_f32_16x16x32_bf16 v[196:199], v[220:223], v[164:167], v[196:199]
    v_perm_b32 v179, v87, v83, s60
    v_perm_b32 v183, v87, v83, s61
    v_mfma_f32_16x16x32_bf16 v[200:203], v[220:223], v[168:171], v[200:203]
    v_mfma_f32_16x16x32_bf16 v[204:207], v[220:223], v[172:175], v[204:207]
    v_mfma_f32_16x16x32_bf16 v[208:211], v[220:223], v[176:179], v[208:211]
    v_mfma_f32_16x16x32_bf16 v[212:215], v[220:223], v[180:183], v[212:215]
    s_waitcnt vmcnt(14)
    v_perm_b32 v152, v92, v88, s60
    v_perm_b32 v156, v92, v88, s61
    v_perm_b32 v160, v93, v89, s60
    v_perm_b32 v164, v93, v89, s61
    v_perm_b32 v168, v94, v90, s60
    v_perm_b32 v172, v94, v90, s61
    v_perm_b32 v176, v95, v91, s60
    v_perm_b32 v180, v95, v91, s61
    s_waitcnt vmcnt(12)
    v_perm_b32 v153, v100, v96, s60
    v_perm_b32 v157, v100, v96, s61
    v_perm_b32 v161, v101, v97, s60
    v_perm_b32 v165, v101, v97, s61
    v_perm_b32 v169, v102, v98, s60
    v_perm_b32 v173, v102, v98, s61
    v_perm_b32 v177, v103, v99, s60
    v_perm_b32 v181, v103, v99, s61
    s_waitcnt vmcnt(10)
    v_perm_b32 v154, v108, v104, s60
    v_perm_b32 v158, v108, v104, s61
    v_perm_b32 v162, v109, v105, s60
    v_perm_b32 v166, v109, v105, s61
    v_perm_b32 v170, v110, v106, s60
    v_perm_b32 v174, v110, v106, s61
    v_perm_b32 v178, v111, v107, s60
    v_perm_b32 v182, v111, v107, s61
    s_waitcnt vmcnt(8)
    v_perm_b32 v155, v116, v112, s60
    v_perm_b32 v159, v116, v112, s61
    v_perm_b32 v163, v117, v113, s60
    v_perm_b32 v167, v117, v113, s61
    v_mfma_f32_16x16x32_bf16 v[184:187], v[224:227], v[152:155], v[184:187]
    v_mfma_f32_16x16x32_bf16 v[188:191], v[224:227], v[156:159], v[188:191]
    v_perm_b32 v171, v118, v114, s60
    v_perm_b32 v175, v118, v114, s61
    v_mfma_f32_16x16x32_bf16 v[192:195], v[224:227], v[160:163], v[192:195]
    v_mfma_f32_16x16x32_bf16 v[196:199], v[224:227], v[164:167], v[196:199]
    v_perm_b32 v179, v119, v115, s60
    v_perm_b32 v183, v119, v115, s61
    v_mfma_f32_16x16x32_bf16 v[200:203], v[224:227], v[168:171], v[200:203]
    v_mfma_f32_16x16x32_bf16 v[204:207], v[224:227], v[172:175], v[204:207]
    v_mfma_f32_16x16x32_bf16 v[208:211], v[224:227], v[176:179], v[208:211]
    v_mfma_f32_16x16x32_bf16 v[212:215], v[224:227], v[180:183], v[212:215]
    s_waitcnt vmcnt(6)
    v_perm_b32 v152, v124, v120, s60
    v_perm_b32 v156, v124, v120, s61
    v_perm_b32 v160, v125, v121, s60
    v_perm_b32 v164, v125, v121, s61
    v_perm_b32 v168, v126, v122, s60
    v_perm_b32 v172, v126, v122, s61
    v_perm_b32 v176, v127, v123, s60
    v_perm_b32 v180, v127, v123, s61
    s_waitcnt vmcnt(4)
    v_perm_b32 v153, v132, v128, s60
    v_perm_b32 v157, v132, v128, s61
    v_perm_b32 v161, v133, v129, s60
    v_perm_b32 v165, v133, v129, s61
    v_perm_b32 v169, v134, v130, s60
    v_perm_b32 v173, v134, v130, s61
    v_perm_b32 v177, v135, v131, s60
    v_perm_b32 v181, v135, v131, s61
    s_waitcnt vmcnt(2)
    v_perm_b32 v154, v140, v136, s60
    v_perm_b32 v158, v140, v136, s61
    v_perm_b32 v162, v141, v137, s60
    v_perm_b32 v166, v141, v137, s61
    v_perm_b32 v170, v142, v138, s60
    v_perm_b32 v174, v142, v138, s61
    v_perm_b32 v178, v143, v139, s60
    v_perm_b32 v182, v143, v139, s61
    s_waitcnt vmcnt(0)
    v_perm_b32 v155, v148, v144, s60
    v_perm_b32 v159, v148, v144, s61
    v_perm_b32 v163, v149, v145, s60
    v_perm_b32 v167, v149, v145, s61
    v_mfma_f32_16x16x32_bf16 v[184:187], v[228:231], v[152:155], v[184:187]
    v_perm_b32 v171, v150, v146, s60
    v_perm_b32 v175, v150, v146, s61
    v_mfma_f32_16x16x32_bf16 v[188:191], v[228:231], v[156:159], v[188:191]
    v_perm_b32 v179, v151, v147, s60
    v_perm_b32 v183, v151, v147, s61
    v_mfma_f32_16x16x32_bf16 v[192:195], v[228:231], v[160:163], v[192:195]
    v_mfma_f32_16x16x32_bf16 v[196:199], v[228:231], v[164:167], v[196:199]
    v_mfma_f32_16x16x32_bf16 v[200:203], v[228:231], v[168:171], v[200:203]
    v_add_f32_dpp v232, v185, v184 row_ror:8 row_mask:0xf bank_mask:0x3
    v_add_f32_dpp v232, v186, v187 row_ror:8 row_mask:0xf bank_mask:0xc
    v_mfma_f32_16x16x32_bf16 v[204:207], v[228:231], v[172:175], v[204:207]
    v_add_f32_dpp v233, v189, v188 row_ror:8 row_mask:0xf bank_mask:0x3
    v_add_f32_dpp v233, v190, v191 row_ror:8 row_mask:0xf bank_mask:0xc
    v_mfma_f32_16x16x32_bf16 v[208:211], v[228:231], v[176:179], v[208:211]
    v_perm_b32 v232, v232, v11, s40
    v_perm_b32 v233, v233, v11, s41
    v_mfma_f32_16x16x32_bf16 v[212:215], v[228:231], v[180:183], v[212:215]
    s_bitcmp1_b32 s57, 1
    s_cbranch_scc1 L_vnext
    v_add_f32_dpp v234, v193, v192 row_ror:8 row_mask:0xf bank_mask:0x3
    v_add_f32_dpp v234, v194, v195 row_ror:8 row_mask:0xf bank_mask:0xc
    v_add_f32_dpp v235, v197, v196 row_ror:8 row_mask:0xf bank_mask:0x3
    v_add_f32_dpp v235, v198, v199 row_ror:8 row_mask:0xf bank_mask:0xc
    v_perm_b32 v234, v234, v11, s42
    v_perm_b32 v235, v235, v11, s43
    s_mov_b64 exec, s[46:47]
    s_bitcmp1_b32 s57, 2
    s_cbranch_scc0 L_vpub_far
    buffer_store_dwordx4 v[232:235], v10, s[28:31], 0 offen
    s_mov_b64 exec, -1
    v_add_f32_dpp v236, v201, v200 row_ror:8 row_mask:0xf bank_mask:0x3
    v_add_f32_dpp v236, v202, v203 row_ror:8 row_mask:0xf bank_mask:0xc
    v_add_f32_dpp v237, v205, v204 row_ror:8 row_mask:0xf bank_mask:0x3
    v_add_f32_dpp v237, v206, v207 row_ror:8 row_mask:0xf bank_mask:0xc
    v_add_f32_dpp v238, v209, v208 row_ror:8 row_mask:0xf bank_mask:0x3
    v_add_f32_dpp v238, v210, v211 row_ror:8 row_mask:0xf bank_mask:0xc
    v_add_f32_dpp v239, v213, v212 row_ror:8 row_mask:0xf bank_mask:0x3
    v_add_f32_dpp v239, v214, v215 row_ror:8 row_mask:0xf bank_mask:0xc
    s_mov_b64 exec, s[46:47]
    v_perm_b32 v236, v236, v11, s40
    v_perm_b32 v237, v237, v11, s41
    v_perm_b32 v238, v238, v11, s42
    v_perm_b32 v239, v239, v11, s43
    buffer_store_dwordx4 v[236:239], v10, s[28:31], 0 offen offset:128
    s_endpgm
L_vpub_far:
    buffer_store_dwordx4 v[232:235], v10, s[28:31], 0 offen sc1
    s_mov_b64 exec, -1
    v_add_f32_dpp v236, v201, v200 row_ror:8 row_mask:0xf bank_mask:0x3
    v_add_f32_dpp v236, v202, v203 row_ror:8 row_mask:0xf bank_mask:0xc
    v_add_f32_dpp v237, v205, v204 row_ror:8 row_mask:0xf bank_mask:0x3
    v_add_f32_dpp v237, v206, v207 row_ror:8 row_mask:0xf bank_mask:0xc
    v_add_f32_dpp v238, v209, v208 row_ror:8 row_mask:0xf bank_mask:0x3
    v_add_f32_dpp v238, v210, v211 row_ror:8 row_mask:0xf bank_mask:0xc
    v_add_f32_dpp v239, v213, v212 row_ror:8 row_mask:0xf bank_mask:0x3
    v_add_f32_dpp v239, v214, v215 row_ror:8 row_mask:0xf bank_mask:0xc
    s_mov_b64 exec, s[46:47]
    v_perm_b32 v236, v236, v11, s40
    v_perm_b32 v237, v237, v11, s41
    v_perm_b32 v238, v238, v11, s42
    v_perm_b32 v239, v239, v11, s43
    buffer_store_dwordx4 v[236:239], v10, s[28:31], 0 offen offset:128 sc1
L_vfin:
    s_endpgm
L_vspecial:
    s_and_b32 s56, s57, 1
    s_cbranch_scc0 L_vresc
    s_bitcmp1_b32 s57, 1
    s_cbranch_scc1 L_vnext
    s_branch L_vfin
L_vresc:
    v_lshrrev_b32 v14, 4, v0
    v_lshlrev_b32 v14, 3, v14
    ds_read_b64 v[16:17], v14 offset:4384
    s_waitcnt lgkmcnt(0)
    v_mul_f32 v184, v184, v16
    v_mul_f32 v185, v185, v16
    v_mul_f32 v186, v186, v17
    v_mul_f32 v187, v187, v17
    v_mul_f32 v188, v188, v16
    v_mul_f32 v189, v189, v16
    v_mul_f32 v190, v190, v17
    v_mul_f32 v191, v191, v17
    v_mul_f32 v192, v192, v16
    v_mul_f32 v193, v193, v16
    v_mul_f32 v194, v194, v17
    v_mul_f32 v195, v195, v17
    v_mul_f32 v196, v196, v16
    v_mul_f32 v197, v197, v16
    v_mul_f32 v198, v198, v17
    v_mul_f32 v199, v199, v17
    v_mul_f32 v200, v200, v16
    v_mul_f32 v201, v201, v16
    v_mul_f32 v202, v202, v17
    v_mul_f32 v203, v203, v17
    v_mul_f32 v204, v204, v16
    v_mul_f32 v205, v205, v16
    v_mul_f32 v206, v206, v17
    v_mul_f32 v207, v207, v17
    v_mul_f32 v208, v208, v16
    v_mul_f32 v209, v209, v16
    v_mul_f32 v210, v210, v17
    v_mul_f32 v211, v211, v17
    v_mul_f32 v212, v212, v16
    v_mul_f32 v213, v213, v16
    v_mul_f32 v214, v214, v17
    v_mul_f32 v215, v215, v17
    s_branch L_vpv
L_vnext:
    s_waitcnt vmcnt(0)
    s_lshl_b32 s56, s55, 7
    v_lshrrev_b32 v14, 1, v6
    v_lshl_add_u32 v14, v14, 3, s56
    ds_read_b32 v4, v14 offset:4480
    v_and_b32 v16, 1, v6
    s_add_u32 s55, s55, 1
    s_waitcnt lgkmcnt(0)
    v_lshl_add_u32 v4, v16, 15, v4
    s_nop 1
    v_readlane_b32 s64, v4, 0
    v_readlane_b32 s65, v4, 1
    v_readlane_b32 s66, v4, 2
    v_readlane_b32 s67, v4, 3
    v_readlane_b32 s68, v4, 4
    v_readlane_b32 s69, v4, 5
    v_readlane_b32 s70, v4, 6
    v_readlane_b32 s71, v4, 7
    v_readlane_b32 s72, v4, 8
    v_readlane_b32 s73, v4, 9
    v_readlane_b32 s74, v4, 10
    v_readlane_b32 s75, v4, 11
    v_readlane_b32 s76, v4, 12
    v_readlane_b32 s77, v4, 13
    v_readlane_b32 s78, v4, 14
    v_readlane_b32 s79, v4, 15
    s_nop 7
    s_branch L_vround
L_knext:
    s_barrier
    s_lshl_b32 s56, s55, 7
    v_lshrrev_b32 v152, 1, v6
    v_lshl_add_u32 v152, v152, 3, s56
    ds_read_b32 v4, v152 offset:4480
    v_add_u32 v164, v152, v216
    ds_read_u8 v5, v164 offset:4484
    v_and_b32 v153, 1, v6
    s_add_u32 s55, s55, 1
    s_waitcnt lgkmcnt(0)
    v_lshl_add_u32 v4, v153, 15, v4
    v_mad_i32_i24 v5, v153, -8, v5
    s_nop 1
    s_sub_u32 s58, s58, 1
    s_cmp_lg_u32 s58, 0
    s_cselect_b32 s57, 2, 0
    v_readlane_b32 s64, v4, 0
    v_readlane_b32 s65, v4, 8
    v_readlane_b32 s66, v4, 16
    v_readlane_b32 s67, v4, 24
    v_readlane_b32 s68, v4, 32
    v_readlane_b32 s69, v4, 40
    v_readlane_b32 s70, v4, 48
    v_readlane_b32 s71, v4, 56
    s_nop 7
    s_branch L_kround
L_slow:
    s_load_dwordx4 s[44:47], s[12:13], 0
    v_lshlrev_b32 v60, 2, v0
    global_load_dword v24, v60, s[10:11] offset:0
    global_load_dword v25, v60, s[10:11] offset:256
    global_load_dword v26, v60, s[10:11] offset:512
    global_load_dword v27, v60, s[10:11] offset:768
    global_load_dword v28, v60, s[10:11] offset:1024
    global_load_dword v29, v60, s[10:11] offset:1280
    global_load_dword v30, v60, s[10:11] offset:1536
    global_load_dword v31, v60, s[10:11] offset:1792
    global_load_dword v32, v60, s[10:11] offset:2048
    global_load_dword v33, v60, s[10:11] offset:2304
    global_load_dword v34, v60, s[10:11] offset:2560
    global_load_dword v35, v60, s[10:11] offset:2816
    global_load_dword v36, v60, s[10:11] offset:3072
    global_load_dword v37, v60, s[10:11] offset:3328
    global_load_dword v38, v60, s[10:11] offset:3584
    global_load_dword v39, v60, s[10:11] offset:3840
    v_cmp_lt_i32 vcc, 0, v212
    s_nop 1
    v_cndmask_b32 v213, 0, v213, vcc
    s_waitcnt vmcnt(0) lgkmcnt(0)
    s_cmp_le_i32 s44, 0
    s_cselect_b32 s44, 4096, s44
    s_min_i32 s44, s44, 4096
    s_cmp_le_i32 s45, 0
    s_cselect_b32 s45, 4096, s45
    s_min_i32 s45, s45, 4096
    s_cmp_le_i32 s46, 0
    s_cselect_b32 s46, 4096, s46
    s_min_i32 s46, s46, 4096
    s_cmp_le_i32 s47, 0
    s_cselect_b32 s47, 4096, s47
    s_min_i32 s47, s47, 4096
    v_lshlrev_b32 v61, 4, v0
    v_add_u32 v61, 0, v61
    v_cmp_gt_i32 vcc, 0, v24
    v_add_u32 v62, 640, v24
    s_nop 0
    v_cndmask_b32 v24, v24, v62, vcc
    v_sub_u32 v56, s44, v61
    v_med3_i32 v56, v56, 0, 16
    v_cmp_lt_i32 vcc, 0, v56
    v_lshlrev_b32 v56, 0, v56
    s_nop 0
    v_cndmask_b32 v24, -1, v24, vcc
    v_cmp_gt_i32 vcc, 0, v28
    v_add_u32 v62, 640, v28
    s_nop 0
    v_cndmask_b32 v28, v28, v62, vcc
    v_sub_u32 v57, s45, v61
    v_med3_i32 v57, v57, 0, 16
    v_cmp_lt_i32 vcc, 0, v57
    v_lshlrev_b32 v57, 8, v57
    s_nop 0
    v_cndmask_b32 v28, -2, v28, vcc
    v_cmp_gt_i32 vcc, 0, v32
    v_add_u32 v62, 640, v32
    s_nop 0
    v_cndmask_b32 v32, v32, v62, vcc
    v_sub_u32 v58, s46, v61
    v_med3_i32 v58, v58, 0, 16
    v_cmp_lt_i32 vcc, 0, v58
    v_lshlrev_b32 v58, 16, v58
    s_nop 0
    v_cndmask_b32 v32, -3, v32, vcc
    v_cmp_gt_i32 vcc, 0, v36
    v_add_u32 v62, 640, v36
    s_nop 0
    v_cndmask_b32 v36, v36, v62, vcc
    v_sub_u32 v59, s47, v61
    v_med3_i32 v59, v59, 0, 16
    v_cmp_lt_i32 vcc, 0, v59
    v_lshlrev_b32 v59, 24, v59
    s_nop 0
    v_cndmask_b32 v36, -4, v36, vcc
    v_mov_b32 v40, v56
    v_cmp_eq_u32 vcc, v24, v28
    s_nop 1
    v_cndmask_b32 v62, 0, v57, vcc
    v_or_b32 v40, v40, v62
    v_cmp_eq_u32 vcc, v24, v32
    s_nop 1
    v_cndmask_b32 v62, 0, v58, vcc
    v_or_b32 v40, v40, v62
    v_cmp_eq_u32 vcc, v24, v36
    s_nop 1
    v_cndmask_b32 v62, 0, v59, vcc
    v_or_b32 v40, v40, v62
    v_mov_b32 v44, v57
    v_cmp_eq_u32 vcc, v28, v32
    s_nop 1
    v_cndmask_b32 v62, 0, v58, vcc
    v_or_b32 v44, v44, v62
    v_cmp_eq_u32 vcc, v28, v36
    s_nop 1
    v_cndmask_b32 v62, 0, v59, vcc
    v_or_b32 v44, v44, v62
    v_cmp_ne_u32 vcc, v28, v24
    s_nop 1
    v_cndmask_b32 v44, 0, v44, vcc
    v_mov_b32 v48, v58
    v_cmp_eq_u32 vcc, v32, v36
    s_nop 1
    v_cndmask_b32 v62, 0, v59, vcc
    v_or_b32 v48, v48, v62
    v_cmp_ne_u32 vcc, v32, v24
    s_nop 1
    v_cndmask_b32 v48, 0, v48, vcc
    v_cmp_ne_u32 vcc, v32, v28
    s_nop 1
    v_cndmask_b32 v48, 0, v48, vcc
    v_mov_b32 v52, v59
    v_cmp_ne_u32 vcc, v36, v24
    s_nop 1
    v_cndmask_b32 v52, 0, v52, vcc
    v_cmp_ne_u32 vcc, v36, v28
    s_nop 1
    v_cndmask_b32 v52, 0, v52, vcc
    v_cmp_ne_u32 vcc, v36, v32
    s_nop 1
    v_cndmask_b32 v52, 0, v52, vcc
    v_lshlrev_b32 v61, 4, v0
    v_add_u32 v61, 1024, v61
    v_cmp_gt_i32 vcc, 0, v25
    v_add_u32 v62, 640, v25
    s_nop 0
    v_cndmask_b32 v25, v25, v62, vcc
    v_sub_u32 v56, s44, v61
    v_med3_i32 v56, v56, 0, 16
    v_cmp_lt_i32 vcc, 0, v56
    v_lshlrev_b32 v56, 0, v56
    s_nop 0
    v_cndmask_b32 v25, -1, v25, vcc
    v_cmp_gt_i32 vcc, 0, v29
    v_add_u32 v62, 640, v29
    s_nop 0
    v_cndmask_b32 v29, v29, v62, vcc
    v_sub_u32 v57, s45, v61
    v_med3_i32 v57, v57, 0, 16
    v_cmp_lt_i32 vcc, 0, v57
    v_lshlrev_b32 v57, 8, v57
    s_nop 0
    v_cndmask_b32 v29, -2, v29, vcc
    v_cmp_gt_i32 vcc, 0, v33
    v_add_u32 v62, 640, v33
    s_nop 0
    v_cndmask_b32 v33, v33, v62, vcc
    v_sub_u32 v58, s46, v61
    v_med3_i32 v58, v58, 0, 16
    v_cmp_lt_i32 vcc, 0, v58
    v_lshlrev_b32 v58, 16, v58
    s_nop 0
    v_cndmask_b32 v33, -3, v33, vcc
    v_cmp_gt_i32 vcc, 0, v37
    v_add_u32 v62, 640, v37
    s_nop 0
    v_cndmask_b32 v37, v37, v62, vcc
    v_sub_u32 v59, s47, v61
    v_med3_i32 v59, v59, 0, 16
    v_cmp_lt_i32 vcc, 0, v59
    v_lshlrev_b32 v59, 24, v59
    s_nop 0
    v_cndmask_b32 v37, -4, v37, vcc
    v_mov_b32 v41, v56
    v_cmp_eq_u32 vcc, v25, v29
    s_nop 1
    v_cndmask_b32 v62, 0, v57, vcc
    v_or_b32 v41, v41, v62
    v_cmp_eq_u32 vcc, v25, v33
    s_nop 1
    v_cndmask_b32 v62, 0, v58, vcc
    v_or_b32 v41, v41, v62
    v_cmp_eq_u32 vcc, v25, v37
    s_nop 1
    v_cndmask_b32 v62, 0, v59, vcc
    v_or_b32 v41, v41, v62
    v_mov_b32 v45, v57
    v_cmp_eq_u32 vcc, v29, v33
    s_nop 1
    v_cndmask_b32 v62, 0, v58, vcc
    v_or_b32 v45, v45, v62
    v_cmp_eq_u32 vcc, v29, v37
    s_nop 1
    v_cndmask_b32 v62, 0, v59, vcc
    v_or_b32 v45, v45, v62
    v_cmp_ne_u32 vcc, v29, v25
    s_nop 1
    v_cndmask_b32 v45, 0, v45, vcc
    v_mov_b32 v49, v58
    v_cmp_eq_u32 vcc, v33, v37
    s_nop 1
    v_cndmask_b32 v62, 0, v59, vcc
    v_or_b32 v49, v49, v62
    v_cmp_ne_u32 vcc, v33, v25
    s_nop 1
    v_cndmask_b32 v49, 0, v49, vcc
    v_cmp_ne_u32 vcc, v33, v29
    s_nop 1
    v_cndmask_b32 v49, 0, v49, vcc
    v_mov_b32 v53, v59
    v_cmp_ne_u32 vcc, v37, v25
    s_nop 1
    v_cndmask_b32 v53, 0, v53, vcc
    v_cmp_ne_u32 vcc, v37, v29
    s_nop 1
    v_cndmask_b32 v53, 0, v53, vcc
    v_cmp_ne_u32 vcc, v37, v33
    s_nop 1
    v_cndmask_b32 v53, 0, v53, vcc
    v_lshlrev_b32 v61, 4, v0
    v_add_u32 v61, 2048, v61
    v_cmp_gt_i32 vcc, 0, v26
    v_add_u32 v62, 640, v26
    s_nop 0
    v_cndmask_b32 v26, v26, v62, vcc
    v_sub_u32 v56, s44, v61
    v_med3_i32 v56, v56, 0, 16
    v_cmp_lt_i32 vcc, 0, v56
    v_lshlrev_b32 v56, 0, v56
    s_nop 0
    v_cndmask_b32 v26, -1, v26, vcc
    v_cmp_gt_i32 vcc, 0, v30
    v_add_u32 v62, 640, v30
    s_nop 0
    v_cndmask_b32 v30, v30, v62, vcc
    v_sub_u32 v57, s45, v61
    v_med3_i32 v57, v57, 0, 16
    v_cmp_lt_i32 vcc, 0, v57
    v_lshlrev_b32 v57, 8, v57
    s_nop 0
    v_cndmask_b32 v30, -2, v30, vcc
    v_cmp_gt_i32 vcc, 0, v34
    v_add_u32 v62, 640, v34
    s_nop 0
    v_cndmask_b32 v34, v34, v62, vcc
    v_sub_u32 v58, s46, v61
    v_med3_i32 v58, v58, 0, 16
    v_cmp_lt_i32 vcc, 0, v58
    v_lshlrev_b32 v58, 16, v58
    s_nop 0
    v_cndmask_b32 v34, -3, v34, vcc
    v_cmp_gt_i32 vcc, 0, v38
    v_add_u32 v62, 640, v38
    s_nop 0
    v_cndmask_b32 v38, v38, v62, vcc
    v_sub_u32 v59, s47, v61
    v_med3_i32 v59, v59, 0, 16
    v_cmp_lt_i32 vcc, 0, v59
    v_lshlrev_b32 v59, 24, v59
    s_nop 0
    v_cndmask_b32 v38, -4, v38, vcc
    v_mov_b32 v42, v56
    v_cmp_eq_u32 vcc, v26, v30
    s_nop 1
    v_cndmask_b32 v62, 0, v57, vcc
    v_or_b32 v42, v42, v62
    v_cmp_eq_u32 vcc, v26, v34
    s_nop 1
    v_cndmask_b32 v62, 0, v58, vcc
    v_or_b32 v42, v42, v62
    v_cmp_eq_u32 vcc, v26, v38
    s_nop 1
    v_cndmask_b32 v62, 0, v59, vcc
    v_or_b32 v42, v42, v62
    v_mov_b32 v46, v57
    v_cmp_eq_u32 vcc, v30, v34
    s_nop 1
    v_cndmask_b32 v62, 0, v58, vcc
    v_or_b32 v46, v46, v62
    v_cmp_eq_u32 vcc, v30, v38
    s_nop 1
    v_cndmask_b32 v62, 0, v59, vcc
    v_or_b32 v46, v46, v62
    v_cmp_ne_u32 vcc, v30, v26
    s_nop 1
    v_cndmask_b32 v46, 0, v46, vcc
    v_mov_b32 v50, v58
    v_cmp_eq_u32 vcc, v34, v38
    s_nop 1
    v_cndmask_b32 v62, 0, v59, vcc
    v_or_b32 v50, v50, v62
    v_cmp_ne_u32 vcc, v34, v26
    s_nop 1
    v_cndmask_b32 v50, 0, v50, vcc
    v_cmp_ne_u32 vcc, v34, v30
    s_nop 1
    v_cndmask_b32 v50, 0, v50, vcc
    v_mov_b32 v54, v59
    v_cmp_ne_u32 vcc, v38, v26
    s_nop 1
    v_cndmask_b32 v54, 0, v54, vcc
    v_cmp_ne_u32 vcc, v38, v30
    s_nop 1
    v_cndmask_b32 v54, 0, v54, vcc
    v_cmp_ne_u32 vcc, v38, v34
    s_nop 1
    v_cndmask_b32 v54, 0, v54, vcc
    v_lshlrev_b32 v61, 4, v0
    v_add_u32 v61, 3072, v61
    v_cmp_gt_i32 vcc, 0, v27
    v_add_u32 v62, 640, v27
    s_nop 0
    v_cndmask_b32 v27, v27, v62, vcc
    v_sub_u32 v56, s44, v61
    v_med3_i32 v56, v56, 0, 16
    v_cmp_lt_i32 vcc, 0, v56
    v_lshlrev_b32 v56, 0, v56
    s_nop 0
    v_cndmask_b32 v27, -1, v27, vcc
    v_cmp_gt_i32 vcc, 0, v31
    v_add_u32 v62, 640, v31
    s_nop 0
    v_cndmask_b32 v31, v31, v62, vcc
    v_sub_u32 v57, s45, v61
    v_med3_i32 v57, v57, 0, 16
    v_cmp_lt_i32 vcc, 0, v57
    v_lshlrev_b32 v57, 8, v57
    s_nop 0
    v_cndmask_b32 v31, -2, v31, vcc
    v_cmp_gt_i32 vcc, 0, v35
    v_add_u32 v62, 640, v35
    s_nop 0
    v_cndmask_b32 v35, v35, v62, vcc
    v_sub_u32 v58, s46, v61
    v_med3_i32 v58, v58, 0, 16
    v_cmp_lt_i32 vcc, 0, v58
    v_lshlrev_b32 v58, 16, v58
    s_nop 0
    v_cndmask_b32 v35, -3, v35, vcc
    v_cmp_gt_i32 vcc, 0, v39
    v_add_u32 v62, 640, v39
    s_nop 0
    v_cndmask_b32 v39, v39, v62, vcc
    v_sub_u32 v59, s47, v61
    v_med3_i32 v59, v59, 0, 16
    v_cmp_lt_i32 vcc, 0, v59
    v_lshlrev_b32 v59, 24, v59
    s_nop 0
    v_cndmask_b32 v39, -4, v39, vcc
    v_mov_b32 v43, v56
    v_cmp_eq_u32 vcc, v27, v31
    s_nop 1
    v_cndmask_b32 v62, 0, v57, vcc
    v_or_b32 v43, v43, v62
    v_cmp_eq_u32 vcc, v27, v35
    s_nop 1
    v_cndmask_b32 v62, 0, v58, vcc
    v_or_b32 v43, v43, v62
    v_cmp_eq_u32 vcc, v27, v39
    s_nop 1
    v_cndmask_b32 v62, 0, v59, vcc
    v_or_b32 v43, v43, v62
    v_mov_b32 v47, v57
    v_cmp_eq_u32 vcc, v31, v35
    s_nop 1
    v_cndmask_b32 v62, 0, v58, vcc
    v_or_b32 v47, v47, v62
    v_cmp_eq_u32 vcc, v31, v39
    s_nop 1
    v_cndmask_b32 v62, 0, v59, vcc
    v_or_b32 v47, v47, v62
    v_cmp_ne_u32 vcc, v31, v27
    s_nop 1
    v_cndmask_b32 v47, 0, v47, vcc
    v_mov_b32 v51, v58
    v_cmp_eq_u32 vcc, v35, v39
    s_nop 1
    v_cndmask_b32 v62, 0, v59, vcc
    v_or_b32 v51, v51, v62
    v_cmp_ne_u32 vcc, v35, v27
    s_nop 1
    v_cndmask_b32 v51, 0, v51, vcc
    v_cmp_ne_u32 vcc, v35, v31
    s_nop 1
    v_cndmask_b32 v51, 0, v51, vcc
    v_mov_b32 v55, v59
    v_cmp_ne_u32 vcc, v39, v27
    s_nop 1
    v_cndmask_b32 v55, 0, v55, vcc
    v_cmp_ne_u32 vcc, v39, v31
    s_nop 1
    v_cndmask_b32 v55, 0, v55, vcc
    v_cmp_ne_u32 vcc, v39, v35
    s_nop 1
    v_cndmask_b32 v55, 0, v55, vcc
    s_mov_b32 s56, 0
    v_cmp_ne_u32 vcc, 0, v40
    s_mov_b32 s68, s56
    s_bcnt1_i32_b64 s40, vcc
    s_add_u32 s56, s56, s40
    v_cmp_ne_u32 vcc, 0, v41
    s_mov_b32 s69, s56
    s_bcnt1_i32_b64 s40, vcc
    s_add_u32 s56, s56, s40
    v_cmp_ne_u32 vcc, 0, v42
    s_mov_b32 s70, s56
    s_bcnt1_i32_b64 s40, vcc
    s_add_u32 s56, s56, s40
    v_cmp_ne_u32 vcc, 0, v43
    s_mov_b32 s71, s56
    s_bcnt1_i32_b64 s40, vcc
    s_add_u32 s56, s56, s40
    v_cmp_ne_u32 vcc, 0, v44
    s_mov_b32 s72, s56
    s_bcnt1_i32_b64 s40, vcc
    s_add_u32 s56, s56, s40
    v_cmp_ne_u32 vcc, 0, v45
    s_mov_b32 s73, s56
    s_bcnt1_i32_b64 s40, vcc
    s_add_u32 s56, s56, s40
    v_cmp_ne_u32 vcc, 0, v46
    s_mov_b32 s74, s56
    s_bcnt1_i32_b64 s40, vcc
    s_add_u32 s56, s56, s40
    v_cmp_ne_u32 vcc, 0, v47
    s_mov_b32 s75, s56
    s_bcnt1_i32_b64 s40, vcc
    s_add_u32 s56, s56, s40
    v_cmp_ne_u32 vcc, 0, v48
    s_mov_b32 s76, s56
    s_bcnt1_i32_b64 s40, vcc
    s_add_u32 s56, s56, s40
    v_cmp_ne_u32 vcc, 0, v49
    s_mov_b32 s77, s56
    s_bcnt1_i32_b64 s40, vcc
    s_add_u32 s56, s56, s40
    v_cmp_ne_u32 vcc, 0, v50
    s_mov_b32 s78, s56
    s_bcnt1_i32_b64 s40, vcc
    s_add_u32 s56, s56, s40
    v_cmp_ne_u32 vcc, 0, v51
    s_mov_b32 s79, s56
    s_bcnt1_i32_b64 s40, vcc
    s_add_u32 s56, s56, s40
    v_cmp_ne_u32 vcc, 0, v52
    s_mov_b32 s80, s56
    s_bcnt1_i32_b64 s40, vcc
    s_add_u32 s56, s56, s40
    v_cmp_ne_u32 vcc, 0, v53
    s_mov_b32 s81, s56
    s_bcnt1_i32_b64 s40, vcc
    s_add_u32 s56, s56, s40
    v_cmp_ne_u32 vcc, 0, v54
    s_mov_b32 s82, s56
    s_bcnt1_i32_b64 s40, vcc
    s_add_u32 s56, s56, s40
    v_cmp_ne_u32 vcc, 0, v55
    s_mov_b32 s83, s56
    s_bcnt1_i32_b64 s40, vcc
    s_add_u32 s56, s56, s40
    s_mul_i32 s40, s21, s56
    s_add_u32 s41, s40, s56
    s_lshr_b32 s40, s40, 5
    s_lshr_b32 s41, s41, 5
    s_sub_u32 s41, s41, s40
    v_and_b32 v61, 31, v0
    v_lshlrev_b32 v61, 3, v61
    v_bfrev_b32 v62, 1
    v_mov_b32 v63, 0
    ds_write_b64 v61, v[62:63] offset:4480
    s_waitcnt lgkmcnt(0)
    v_cmp_ne_u32 s[42:43], 0, v40
    s_sub_u32 s56, s68, s40
    v_lshl_add_u32 v62, v24, 16, s53
    v_mov_b32 v63, v40
    v_mbcnt_lo_u32_b32 v61, s42, 0
    v_mbcnt_hi_u32_b32 v61, s43, v61
    v_add_u32 v61, s56, v61
    v_cmp_gt_u32 vcc, s41, v61
    v_lshlrev_b32 v61, 3, v61
    s_and_b64 exec, vcc, s[42:43]
    ds_write_b64 v61, v[62:63] offset:4480
    s_mov_b64 exec, -1
    s_waitcnt lgkmcnt(0)
    v_cmp_ne_u32 s[42:43], 0, v41
    s_sub_u32 s56, s69, s40
    v_lshl_add_u32 v62, v25, 16, s53
    v_mov_b32 v63, v41
    v_mbcnt_lo_u32_b32 v61, s42, 0
    v_mbcnt_hi_u32_b32 v61, s43, v61
    v_add_u32 v61, s56, v61
    v_cmp_gt_u32 vcc, s41, v61
    v_lshlrev_b32 v61, 3, v61
    s_and_b64 exec, vcc, s[42:43]
    ds_write_b64 v61, v[62:63] offset:4480
    s_mov_b64 exec, -1
    s_waitcnt lgkmcnt(0)
    v_cmp_ne_u32 s[42:43], 0, v42
    s_sub_u32 s56, s70, s40
    v_lshl_add_u32 v62, v26, 16, s53
    v_mov_b32 v63, v42
    v_mbcnt_lo_u32_b32 v61, s42, 0
    v_mbcnt_hi_u32_b32 v61, s43, v61
    v_add_u32 v61, s56, v61
    v_cmp_gt_u32 vcc, s41, v61
    v_lshlrev_b32 v61, 3, v61
    s_and_b64 exec, vcc, s[42:43]
    ds_write_b64 v61, v[62:63] offset:4480
    s_mov_b64 exec, -1
    s_waitcnt lgkmcnt(0)
    v_cmp_ne_u32 s[42:43], 0, v43
    s_sub_u32 s56, s71, s40
    v_lshl_add_u32 v62, v27, 16, s53
    v_mov_b32 v63, v43
    v_mbcnt_lo_u32_b32 v61, s42, 0
    v_mbcnt_hi_u32_b32 v61, s43, v61
    v_add_u32 v61, s56, v61
    v_cmp_gt_u32 vcc, s41, v61
    v_lshlrev_b32 v61, 3, v61
    s_and_b64 exec, vcc, s[42:43]
    ds_write_b64 v61, v[62:63] offset:4480
    s_mov_b64 exec, -1
    s_waitcnt lgkmcnt(0)
    v_cmp_ne_u32 s[42:43], 0, v44
    s_sub_u32 s56, s72, s40
    v_lshl_add_u32 v62, v28, 16, s53
    v_mov_b32 v63, v44
    v_mbcnt_lo_u32_b32 v61, s42, 0
    v_mbcnt_hi_u32_b32 v61, s43, v61
    v_add_u32 v61, s56, v61
    v_cmp_gt_u32 vcc, s41, v61
    v_lshlrev_b32 v61, 3, v61
    s_and_b64 exec, vcc, s[42:43]
    ds_write_b64 v61, v[62:63] offset:4480
    s_mov_b64 exec, -1
    s_waitcnt lgkmcnt(0)
    v_cmp_ne_u32 s[42:43], 0, v45
    s_sub_u32 s56, s73, s40
    v_lshl_add_u32 v62, v29, 16, s53
    v_mov_b32 v63, v45
    v_mbcnt_lo_u32_b32 v61, s42, 0
    v_mbcnt_hi_u32_b32 v61, s43, v61
    v_add_u32 v61, s56, v61
    v_cmp_gt_u32 vcc, s41, v61
    v_lshlrev_b32 v61, 3, v61
    s_and_b64 exec, vcc, s[42:43]
    ds_write_b64 v61, v[62:63] offset:4480
    s_mov_b64 exec, -1
    s_waitcnt lgkmcnt(0)
    v_cmp_ne_u32 s[42:43], 0, v46
    s_sub_u32 s56, s74, s40
    v_lshl_add_u32 v62, v30, 16, s53
    v_mov_b32 v63, v46
    v_mbcnt_lo_u32_b32 v61, s42, 0
    v_mbcnt_hi_u32_b32 v61, s43, v61
    v_add_u32 v61, s56, v61
    v_cmp_gt_u32 vcc, s41, v61
    v_lshlrev_b32 v61, 3, v61
    s_and_b64 exec, vcc, s[42:43]
    ds_write_b64 v61, v[62:63] offset:4480
    s_mov_b64 exec, -1
    s_waitcnt lgkmcnt(0)
    v_cmp_ne_u32 s[42:43], 0, v47
    s_sub_u32 s56, s75, s40
    v_lshl_add_u32 v62, v31, 16, s53
    v_mov_b32 v63, v47
    v_mbcnt_lo_u32_b32 v61, s42, 0
    v_mbcnt_hi_u32_b32 v61, s43, v61
    v_add_u32 v61, s56, v61
    v_cmp_gt_u32 vcc, s41, v61
    v_lshlrev_b32 v61, 3, v61
    s_and_b64 exec, vcc, s[42:43]
    ds_write_b64 v61, v[62:63] offset:4480
    s_mov_b64 exec, -1
    s_waitcnt lgkmcnt(0)
    v_cmp_ne_u32 s[42:43], 0, v48
    s_sub_u32 s56, s76, s40
    v_lshl_add_u32 v62, v32, 16, s53
    v_mov_b32 v63, v48
    v_mbcnt_lo_u32_b32 v61, s42, 0
    v_mbcnt_hi_u32_b32 v61, s43, v61
    v_add_u32 v61, s56, v61
    v_cmp_gt_u32 vcc, s41, v61
    v_lshlrev_b32 v61, 3, v61
    s_and_b64 exec, vcc, s[42:43]
    ds_write_b64 v61, v[62:63] offset:4480
    s_mov_b64 exec, -1
    s_waitcnt lgkmcnt(0)
    v_cmp_ne_u32 s[42:43], 0, v49
    s_sub_u32 s56, s77, s40
    v_lshl_add_u32 v62, v33, 16, s53
    v_mov_b32 v63, v49
    v_mbcnt_lo_u32_b32 v61, s42, 0
    v_mbcnt_hi_u32_b32 v61, s43, v61
    v_add_u32 v61, s56, v61
    v_cmp_gt_u32 vcc, s41, v61
    v_lshlrev_b32 v61, 3, v61
    s_and_b64 exec, vcc, s[42:43]
    ds_write_b64 v61, v[62:63] offset:4480
    s_mov_b64 exec, -1
    s_waitcnt lgkmcnt(0)
    v_cmp_ne_u32 s[42:43], 0, v50
    s_sub_u32 s56, s78, s40
    v_lshl_add_u32 v62, v34, 16, s53
    v_mov_b32 v63, v50
    v_mbcnt_lo_u32_b32 v61, s42, 0
    v_mbcnt_hi_u32_b32 v61, s43, v61
    v_add_u32 v61, s56, v61
    v_cmp_gt_u32 vcc, s41, v61
    v_lshlrev_b32 v61, 3, v61
    s_and_b64 exec, vcc, s[42:43]
    ds_write_b64 v61, v[62:63] offset:4480
    s_mov_b64 exec, -1
    s_waitcnt lgkmcnt(0)
    v_cmp_ne_u32 s[42:43], 0, v51
    s_sub_u32 s56, s79, s40
    v_lshl_add_u32 v62, v35, 16, s53
    v_mov_b32 v63, v51
    v_mbcnt_lo_u32_b32 v61, s42, 0
    v_mbcnt_hi_u32_b32 v61, s43, v61
    v_add_u32 v61, s56, v61
    v_cmp_gt_u32 vcc, s41, v61
    v_lshlrev_b32 v61, 3, v61
    s_and_b64 exec, vcc, s[42:43]
    ds_write_b64 v61, v[62:63] offset:4480
    s_mov_b64 exec, -1
    s_waitcnt lgkmcnt(0)
    v_cmp_ne_u32 s[42:43], 0, v52
    s_sub_u32 s56, s80, s40
    v_lshl_add_u32 v62, v36, 16, s53
    v_mov_b32 v63, v52
    v_mbcnt_lo_u32_b32 v61, s42, 0
    v_mbcnt_hi_u32_b32 v61, s43, v61
    v_add_u32 v61, s56, v61
    v_cmp_gt_u32 vcc, s41, v61
    v_lshlrev_b32 v61, 3, v61
    s_and_b64 exec, vcc, s[42:43]
    ds_write_b64 v61, v[62:63] offset:4480
    s_mov_b64 exec, -1
    s_waitcnt lgkmcnt(0)
    v_cmp_ne_u32 s[42:43], 0, v53
    s_sub_u32 s56, s81, s40
    v_lshl_add_u32 v62, v37, 16, s53
    v_mov_b32 v63, v53
    v_mbcnt_lo_u32_b32 v61, s42, 0
    v_mbcnt_hi_u32_b32 v61, s43, v61
    v_add_u32 v61, s56, v61
    v_cmp_gt_u32 vcc, s41, v61
    v_lshlrev_b32 v61, 3, v61
    s_and_b64 exec, vcc, s[42:43]
    ds_write_b64 v61, v[62:63] offset:4480
    s_mov_b64 exec, -1
    s_waitcnt lgkmcnt(0)
    v_cmp_ne_u32 s[42:43], 0, v54
    s_sub_u32 s56, s82, s40
    v_lshl_add_u32 v62, v38, 16, s53
    v_mov_b32 v63, v54
    v_mbcnt_lo_u32_b32 v61, s42, 0
    v_mbcnt_hi_u32_b32 v61, s43, v61
    v_add_u32 v61, s56, v61
    v_cmp_gt_u32 vcc, s41, v61
    v_lshlrev_b32 v61, 3, v61
    s_and_b64 exec, vcc, s[42:43]
    ds_write_b64 v61, v[62:63] offset:4480
    s_mov_b64 exec, -1
    s_waitcnt lgkmcnt(0)
    v_cmp_ne_u32 s[42:43], 0, v55
    s_sub_u32 s56, s83, s40
    v_lshl_add_u32 v62, v39, 16, s53
    v_mov_b32 v63, v55
    v_mbcnt_lo_u32_b32 v61, s42, 0
    v_mbcnt_hi_u32_b32 v61, s43, v61
    v_add_u32 v61, s56, v61
    v_cmp_gt_u32 vcc, s41, v61
    v_lshlrev_b32 v61, 3, v61
    s_and_b64 exec, vcc, s[42:43]
    ds_write_b64 v61, v[62:63] offset:4480
    s_mov_b64 exec, -1
    s_waitcnt lgkmcnt(0)
    s_add_u32 s58, s41, 15
    s_lshr_b32 s58, s58, 4
    v_mov_b32 v5, 0
    s_cmp_lg_u32 s58, 0
    s_cselect_b32 s57, 3, 1
    s_branch L_kverified
.section .rodata,"a"
.p2align 6
.amdhsa_kernel standalone__paged_block_table_kv_radixattention__decode_kernel
  .amdhsa_next_free_vgpr 256
  .amdhsa_next_free_sgpr 102
  .amdhsa_accum_offset 256
  .amdhsa_group_segment_fixed_size 0
  .amdhsa_kernarg_size 64
  .amdhsa_user_sgpr_count 2
  .amdhsa_user_sgpr_kernarg_segment_ptr 1
  .amdhsa_system_sgpr_workgroup_id_x 1
.end_amdhsa_kernel
```
